```python
import torch

def _softmax(x, axis=-1):
    return torch.softmax(x, dim=axis)
def _gelu(x):
    return torch.nn.functional.gelu(x, approximate="tanh")
def _silu(x):
    return torch.nn.functional.silu(x)
def _sigmoid(x):
    return torch.sigmoid(x)
def _layernorm(x, axis=-1, eps=1e-5):
    m = x.mean(dim=axis, keepdim=True)
    v = x.var(dim=axis, keepdim=True, unbiased=False)
    return (x - m) / torch.sqrt(v + eps)
def _scatter_add(tgt, idx, src, axis=0):
    return tgt.clone().index_add_(axis, idx, src)
def _segment_sum(src, seg, n):
    out = torch.zeros((n,) + src.shape[1:], dtype=src.dtype)
    return out.index_add_(0, seg, src)
def _pad(x, pw):
    flat = tuple(v for pair in reversed(pw) for v in pair)
    return torch.nn.functional.pad(x, flat)

kernel_name = 'standalone__ssm_conv_s4d__prompt'

def setup_inputs():

    _w = (lambda a: (lambda t: t.to(torch.bfloat16) if t.is_floating_point() else t)(torch.as_tensor(a)))
    Bsz, L, D, N = 1, 2048, 640, 192
    return {
        "u": _w((lambda *s: torch.randn(*s, dtype=torch.bfloat16) * 0.05)(Bsz, L, D)),
        "log_A_real": _w((lambda *s: torch.randn(*s, dtype=torch.bfloat16) * 6.4)(D, N) * 0.5),
        "A_imag": _w((lambda *s: torch.randn(*s, dtype=torch.bfloat16) * 0.05)(D, N) * 3.14),
        "C_real": _w((lambda *s: torch.randn(*s, dtype=torch.bfloat16) * 0.05)(D, N) / N ** 0.5),
        "C_imag": _w((lambda *s: torch.randn(*s, dtype=torch.bfloat16) * 0.05)(D, N) / N ** 0.5),
        "log_dt": _w((lambda *s: torch.randn(*s, dtype=torch.bfloat16) * 0.05)(D) * 0.5 - 4.0),
        "D_skip": _w((lambda *s: torch.randn(*s, dtype=torch.bfloat16) * 0.05)(D)),
    }

def reference(u, log_A_real, A_imag, C_real, C_imag, log_dt, D_skip):
    L = u.shape[1]
    dt = torch.exp(log_dt)
    A = -torch.exp(log_A_real) + 1j * A_imag
    C = (C_real + 1j * C_imag) * dt[:, None]
    pos = (lambda x, dt: x.to(dt))(torch.arange(L), log_dt.dtype)
    P = torch.exp((A * dt[:, None])[:, :, None] * pos[None, None, :])
    K = 2.0 * torch.einsum("dn,dnl->dl", C, P).real
    L2 = 2 * L
    u_t = (lambda x, *d: x.permute(*d))(u, 0, 2, 1)
    Kf = (lambda x, *a, **k: torch.fft.rfft(x.float(), *a, **k))(K, L2)
    Uf = (lambda x, *a, **k: torch.fft.rfft(x.float(), *a, **k))(u_t, L2)
    y = (lambda x, *a, **k: torch.fft.irfft(x, *a, **k).to(torch.bfloat16))(Uf * Kf[None, :, :], L2)[:, :, :L]
    y = (lambda x, *d: x.permute(*d))(y, 0, 2, 1)
    return y + u * D_skip[None, None, :]
```

```asm
; @launch grid=(160,1,1) block=(1024,1,1) lds=160416
.amdgcn_target "amdgcn-amd-amdhsa--gfx950"
.text
.globl standalone__ssm_conv_s4d__prompt_kernel
.p2align 8
.type standalone__ssm_conv_s4d__prompt_kernel,@function
standalone__ssm_conv_s4d__prompt_kernel:
    s_cmp_ge_u32 s2, 160
    s_cbranch_scc1 L_end
    s_load_dwordx16 s[16:31], s[0:1], 0
    s_getpc_b64 s[58:59]
L_pc:
    v_subrev_u32 v2, 768, v0
    v_lshlrev_b32 v2, 6, v2
    v_cmp_gt_u32 vcc, L_code_end-L_pc-4, v2
    s_and_saveexec_b64 s[54:55], vcc
    s_cbranch_execz L_nopf
    global_load_dword v127, v2, s[58:59]
L_nopf:
    s_mov_b64 exec, -1
    s_lshr_b32 s5, s2, 3
    s_lshl_b32 s6, s5, 10
    v_add_u32 v124, s6, v0
    s_mov_b32 s6, 0x1999999a
    v_mul_hi_u32 v125, v124, s6
    v_mul_u32_u24 v123, 10, v125
    v_sub_u32 v124, v124, v123
    v_mul_u32_u24 v125, 1280, v125
    v_lshl_add_u32 v124, v124, 4, v125
    s_and_b32 s4, s2, 7
    s_mul_i32 s6, s4, 160
    v_add_u32 v124, s6, v124
    v_lshrrev_b32 v1, 6, v0
    v_and_b32 v0, 63, v0
    v_readfirstlane_b32 s3, v1
    s_mul_i32 s4, s4, 20
    s_add_u32 s4, s4, s5
    v_mov_b32 v125, 152192
    v_mov_b32 v126, 1
    s_cmp_ge_u32 s3, 12
    s_cbranch_scc1 L_io
    s_and_b32 s5, s3, 3
    s_lshr_b32 s6, s3, 2
    s_lshl_b32 s7, s4, 2
    s_add_u32 s7, s7, s5
    s_mul_i32 s8, s7, 384
    s_lshl_b32 s9, s6, 7
    s_add_u32 s8, s8, s9
    v_lshl_add_u32 v1, v0, 1, s8
    v_mov_b32 v2, 0
    v_mov_b32 v3, 0
    v_mov_b32 v4, 0
    v_mov_b32 v5, 0
    s_lshl_b32 s9, s7, 1
    s_and_b32 s9, s9, 0xfffffffc
    s_mul_i32 s11, s3, 4352
    s_mov_b32 m0, s11
    s_mov_b32 s40, 0x3fb8aa00
    s_mov_b32 s41, 0x36eca570
    s_waitcnt lgkmcnt(0)
    s_load_dword s10, s[26:27], s9
    global_load_short_d16_hi v2, v1, s[18:19]
    global_load_short_d16_hi v3, v1, s[20:21]
    global_load_short_d16_hi v4, v1, s[22:23]
    global_load_short_d16_hi v5, v1, s[24:25]
    global_load_dwordx4 v[120:123], v124, s[16:17]
    s_barrier
    v_add_u32 v6, 12, v0
    v_and_b32 v6, 15, v6
    v_bfe_u32 v7, v6, 1, 2
    v_and_b32 v8, 1, v6
    v_lshl_add_u32 v7, v8, 3, v7
    v_lshrrev_b32 v8, 3, v6
    v_lshl_add_u32 v7, v8, 2, v7
    v_mul_u32_u24 v116, 272, v7
    v_bfe_u32 v8, v0, 4, 1
    v_lshl_add_u32 v116, v8, 7, v116
    v_lshrrev_b32 v8, 5, v0
    v_lshl_add_u32 v116, v8, 6, v116
    v_add_u32 v116, s11, v116
    s_setprio 3
    s_mul_i32 s14, s5, 8448
    s_add_u32 s14, s14, 52224
    v_lshlrev_b32 v118, 4, v0
    s_lshl_b32 s44, s5, 11
    s_lshl_b32 s13, s6, 9
    s_add_u32 s44, s44, s13
    s_add_u32 s44, s44, 152224
    s_lshl_b32 s12, s5, 5
    s_add_u32 s12, s12, 152064
    v_mov_b32 v125, s12
    v_and_b32 v6, 15, v0
    v_lshrrev_b32 v7, 4, v0
    v_lshlrev_b32 v6, 5, v6
    s_cmp_eq_u32 s6, 1
    s_cbranch_scc1 L_pre1
    s_cmp_eq_u32 s6, 2
    s_cbranch_scc1 L_pre2
    v_lshlrev_b32 v119, 5, v0
    s_add_u32 s15, s14, 2016
    v_sub_u32 v119, s15, v119
    v_add_u32 v127, 16, v118
    v_cmp_eq_u32 vcc, 63, v0
    s_nop 1
    v_cndmask_b32 v127, v127, 12, vcc
    v_add_u32 v127, s14, v127
    s_add_u32 s13, s14, 1024
    s_branch L_pre_done
L_pre1:
    v_lshl_add_u32 v119, v7, 3, v6
    s_add_u32 s15, s14, 4096
    v_sub_u32 v119, s15, v119
    s_mov_b32 s13, s14
    s_branch L_pre_done
L_pre2:
    v_lshl_add_u32 v119, v7, 9, v6
    v_lshl_add_u32 v8, v7, 4, v6
    v_add_u32 v8, 512, v8
    v_cmp_gt_u32 vcc, 32, v0
    s_nop 1
    v_cndmask_b32 v119, v119, v8, vcc
    s_add_u32 s15, s14, 4064
    v_sub_u32 v119, s15, v119
    v_add_u32 v127, 1, v0
    v_add_u32 v8, 16, v0
    v_cmp_gt_u32 vcc, 16, v0
    s_nop 1
    v_cndmask_b32 v127, v127, v8, vcc
    v_subrev_u32 v8, 15, v0
    v_cmp_eq_u32 vcc, 1, v7
    v_cmp_ne_u32 s[42:43], 31, v0
    s_and_b64 vcc, vcc, s[42:43]
    v_cndmask_b32 v127, v127, v8, vcc
    v_lshlrev_b32 v127, 4, v127
    s_mul_i32 s15, s5, 4352
    v_add_u32 v127, s15, v127
    v_cmp_eq_u32 s[42:43], 31, v0
    s_add_u32 s13, s14, 4240
L_pre_done:
    v_add_u32 v117, s13, v118
    s_waitcnt lgkmcnt(0)
    s_lshl_b32 s12, s10, 16
    s_and_b32 s13, s10, 0xffff0000
    s_bitcmp1_b32 s7, 0
    s_cselect_b32 s10, s13, s12
    v_mov_b32 v6, s10
    v_mul_f32 v7, s40, v6
    v_mul_f32 v8, s41, v6
    v_exp_f32 v7, v7
    v_exp_f32 v8, v8
    s_nop 0
    v_mul_f32 v7, v7, v8
    v_cvt_pk_bf16_f32 v7, v7, v7
    v_and_b32 v6, 0xffff0000, v7
    s_waitcnt vmcnt(4)
    v_mul_f32 v7, s40, v2
    v_mul_f32 v8, s41, v2
    v_exp_f32 v7, v7
    v_exp_f32 v8, v8
    s_nop 0
    v_mul_f32 v7, v7, v8
    v_cvt_pk_bf16_f32 v7, v7, v7
    v_and_b32 v2, 0xffff0000, v7
    v_mul_f32 v2, v2, v6
    v_mul_f32 v2, 0xbfb8aa3b, v2
    s_waitcnt vmcnt(3)
    v_mul_f32 v3, v3, v6
    v_mul_f32 v3, 0.15915494, v3
    v_add_f32 v6, v6, v6
    v_mul_f32 v7, 0x41800000, v2
    v_mul_f32 v8, 0x43800000, v2
    v_mul_f32 v9, 0x41800000, v3
    v_mul_f32 v10, 0x43800000, v3
    v_fract_f32 v3, v3
    v_fract_f32 v9, v9
    v_fract_f32 v10, v10
    v_exp_f32 v7, v7
    v_cos_f32 v11, v9
    v_sin_f32 v12, v9
    v_exp_f32 v2, v2
    v_cos_f32 v13, v3
    v_sin_f32 v14, v3
    v_mul_f32 v46, v7, v11
    v_mul_f32 v47, -v7, v12
    v_exp_f32 v8, v8
    v_cos_f32 v11, v10
    v_sin_f32 v12, v10
    v_mul_f32 v16, v2, v13
    v_mul_f32 v17, v2, v14
    s_waitcnt vmcnt(1)
    v_mul_f32 v64, v4, v6
    v_mul_f32 v65, -v5, v6
    v_mul_f32 v48, v8, v11
    v_mul_f32 v49, v8, v12
    v_pk_mul_f32 v[66:67], v[64:65], v[46:47] op_sel:[0,0] op_sel_hi:[0,1]
    v_pk_mul_f32 v[18:19], v[16:17], v[16:17] op_sel:[0,0] op_sel_hi:[0,1]
    v_cvt_pk_bf16_f32 v68, v64, v65
    ds_write_addtid_b32 v68 offset:1632
    v_pk_fma_f32 v[66:67], v[64:65], v[46:47], v[66:67] op_sel:[1,1,0] op_sel_hi:[1,0,1] neg_lo:[0,1,0]
    v_pk_fma_f32 v[18:19], v[16:17], v[16:17], v[18:19] op_sel:[1,1,0] op_sel_hi:[1,0,1] neg_lo:[0,1,0]
    v_pk_mul_f32 v[64:65], v[66:67], v[46:47] op_sel:[0,0] op_sel_hi:[0,1]
    v_pk_mul_f32 v[50:51], v[48:49], v[48:49] op_sel:[0,0] op_sel_hi:[0,1]
    v_cvt_pk_bf16_f32 v69, v66, v67
    ds_write_addtid_b32 v69 offset:3808
    v_pk_fma_f32 v[64:65], v[66:67], v[46:47], v[64:65] op_sel:[1,1,0] op_sel_hi:[1,0,1] neg_lo:[0,1,0]
    v_pk_fma_f32 v[50:51], v[48:49], v[48:49], v[50:51] op_sel:[1,1,0] op_sel_hi:[1,0,1] neg_lo:[0,1,0]
    v_pk_mul_f32 v[66:67], v[64:65], v[46:47] op_sel:[0,0] op_sel_hi:[0,1]
    v_pk_mul_f32 v[22:23], v[18:19], v[18:19] op_sel:[0,0] op_sel_hi:[0,1]
    v_cvt_pk_bf16_f32 v70, v64, v65
    ds_write_addtid_b32 v70 offset:1904
    v_pk_fma_f32 v[66:67], v[64:65], v[46:47], v[66:67] op_sel:[1,1,0] op_sel_hi:[1,0,1] neg_lo:[0,1,0]
    v_pk_fma_f32 v[22:23], v[18:19], v[18:19], v[22:23] op_sel:[1,1,0] op_sel_hi:[1,0,1] neg_lo:[0,1,0]
    v_pk_mul_f32 v[64:65], v[66:67], v[46:47] op_sel:[0,0] op_sel_hi:[0,1]
    v_pk_mul_f32 v[52:53], v[50:51], v[48:49] op_sel:[0,0] op_sel_hi:[0,1]
    v_cvt_pk_bf16_f32 v71, v66, v67
    ds_write_addtid_b32 v71 offset:4080
    v_pk_fma_f32 v[64:65], v[66:67], v[46:47], v[64:65] op_sel:[1,1,0] op_sel_hi:[1,0,1] neg_lo:[0,1,0]
    v_pk_fma_f32 v[52:53], v[50:51], v[48:49], v[52:53] op_sel:[1,1,0] op_sel_hi:[1,0,1] neg_lo:[0,1,0]
    v_pk_mul_f32 v[66:67], v[64:65], v[46:47] op_sel:[0,0] op_sel_hi:[0,1]
    v_pk_mul_f32 v[54:55], v[50:51], v[50:51] op_sel:[0,0] op_sel_hi:[0,1]
    v_cvt_pk_bf16_f32 v68, v64, v65
    ds_write_addtid_b32 v68 offset:0
    v_pk_fma_f32 v[66:67], v[64:65], v[46:47], v[66:67] op_sel:[1,1,0] op_sel_hi:[1,0,1] neg_lo:[0,1,0]
    v_pk_fma_f32 v[54:55], v[50:51], v[50:51], v[54:55] op_sel:[1,1,0] op_sel_hi:[1,0,1] neg_lo:[0,1,0]
    v_pk_mul_f32 v[64:65], v[66:67], v[46:47] op_sel:[0,0] op_sel_hi:[0,1]
    v_pk_mul_f32 v[30:31], v[22:23], v[22:23] op_sel:[0,0] op_sel_hi:[0,1]
    v_cvt_pk_bf16_f32 v69, v66, v67
    ds_write_addtid_b32 v69 offset:2176
    v_pk_fma_f32 v[64:65], v[66:67], v[46:47], v[64:65] op_sel:[1,1,0] op_sel_hi:[1,0,1] neg_lo:[0,1,0]
    v_pk_fma_f32 v[30:31], v[22:23], v[22:23], v[30:31] op_sel:[1,1,0] op_sel_hi:[1,0,1] neg_lo:[0,1,0]
    v_pk_mul_f32 v[66:67], v[64:65], v[46:47] op_sel:[0,0] op_sel_hi:[0,1]
    v_pk_mul_f32 v[56:57], v[54:55], v[48:49] op_sel:[0,0] op_sel_hi:[0,1]
    v_cvt_pk_bf16_f32 v70, v64, v65
    ds_write_addtid_b32 v70 offset:272
    v_pk_fma_f32 v[66:67], v[64:65], v[46:47], v[66:67] op_sel:[1,1,0] op_sel_hi:[1,0,1] neg_lo:[0,1,0]
    v_pk_fma_f32 v[56:57], v[54:55], v[48:49], v[56:57] op_sel:[1,1,0] op_sel_hi:[1,0,1] neg_lo:[0,1,0]
    v_pk_mul_f32 v[64:65], v[66:67], v[46:47] op_sel:[0,0] op_sel_hi:[0,1]
    v_pk_mul_f32 v[58:59], v[54:55], v[50:51] op_sel:[0,0] op_sel_hi:[0,1]
    v_cvt_pk_bf16_f32 v71, v66, v67
    ds_write_addtid_b32 v71 offset:2448
    v_pk_fma_f32 v[64:65], v[66:67], v[46:47], v[64:65] op_sel:[1,1,0] op_sel_hi:[1,0,1] neg_lo:[0,1,0]
    v_pk_fma_f32 v[58:59], v[54:55], v[50:51], v[58:59] op_sel:[1,1,0] op_sel_hi:[1,0,1] neg_lo:[0,1,0]
    v_pk_mul_f32 v[66:67], v[64:65], v[46:47] op_sel:[0,0] op_sel_hi:[0,1]
    v_pk_mul_f32 v[60:61], v[54:55], v[52:53] op_sel:[0,0] op_sel_hi:[0,1]
    v_cvt_pk_bf16_f32 v68, v64, v65
    ds_write_addtid_b32 v68 offset:544
    v_pk_fma_f32 v[66:67], v[64:65], v[46:47], v[66:67] op_sel:[1,1,0] op_sel_hi:[1,0,1] neg_lo:[0,1,0]
    v_pk_fma_f32 v[60:61], v[54:55], v[52:53], v[60:61] op_sel:[1,1,0] op_sel_hi:[1,0,1] neg_lo:[0,1,0]
    v_pk_mul_f32 v[64:65], v[66:67], v[46:47] op_sel:[0,0] op_sel_hi:[0,1]
    v_pk_mul_f32 v[62:63], v[54:55], v[54:55] op_sel:[0,0] op_sel_hi:[0,1]
    v_cvt_pk_bf16_f32 v69, v66, v67
    ds_write_addtid_b32 v69 offset:2720
    v_pk_fma_f32 v[64:65], v[66:67], v[46:47], v[64:65] op_sel:[1,1,0] op_sel_hi:[1,0,1] neg_lo:[0,1,0]
    v_pk_fma_f32 v[62:63], v[54:55], v[54:55], v[62:63] op_sel:[1,1,0] op_sel_hi:[1,0,1] neg_lo:[0,1,0]
    v_pk_mul_f32 v[66:67], v[64:65], v[46:47] op_sel:[0,0] op_sel_hi:[0,1]
    v_pk_mul_f32 v[32:33], v[54:55], v[30:31] op_sel:[0,0] op_sel_hi:[0,1]
    v_cvt_pk_bf16_f32 v70, v64, v65
    ds_write_addtid_b32 v70 offset:816
    v_pk_fma_f32 v[66:67], v[64:65], v[46:47], v[66:67] op_sel:[1,1,0] op_sel_hi:[1,0,1] neg_lo:[0,1,0]
    v_pk_fma_f32 v[32:33], v[54:55], v[30:31], v[32:33] op_sel:[1,1,0] op_sel_hi:[1,0,1] neg_lo:[0,1,0]
    v_pk_mul_f32 v[64:65], v[66:67], v[46:47] op_sel:[0,0] op_sel_hi:[0,1]
    v_pk_mul_f32 v[34:35], v[56:57], v[30:31] op_sel:[0,0] op_sel_hi:[0,1]
    v_cvt_pk_bf16_f32 v71, v66, v67
    ds_write_addtid_b32 v71 offset:2992
    v_pk_fma_f32 v[64:65], v[66:67], v[46:47], v[64:65] op_sel:[1,1,0] op_sel_hi:[1,0,1] neg_lo:[0,1,0]
    v_pk_fma_f32 v[34:35], v[56:57], v[30:31], v[34:35] op_sel:[1,1,0] op_sel_hi:[1,0,1] neg_lo:[0,1,0]
    v_pk_mul_f32 v[66:67], v[64:65], v[46:47] op_sel:[0,0] op_sel_hi:[0,1]
    v_pk_mul_f32 v[36:37], v[58:59], v[30:31] op_sel:[0,0] op_sel_hi:[0,1]
    v_cvt_pk_bf16_f32 v68, v64, v65
    ds_write_addtid_b32 v68 offset:1088
    v_pk_fma_f32 v[66:67], v[64:65], v[46:47], v[66:67] op_sel:[1,1,0] op_sel_hi:[1,0,1] neg_lo:[0,1,0]
    v_pk_fma_f32 v[36:37], v[58:59], v[30:31], v[36:37] op_sel:[1,1,0] op_sel_hi:[1,0,1] neg_lo:[0,1,0]
    v_pk_mul_f32 v[64:65], v[66:67], v[46:47] op_sel:[0,0] op_sel_hi:[0,1]
    v_pk_mul_f32 v[40:41], v[60:61], v[30:31] op_sel:[0,0] op_sel_hi:[0,1]
    v_cvt_pk_bf16_f32 v69, v66, v67
    ds_write_addtid_b32 v69 offset:3264
    v_pk_fma_f32 v[64:65], v[66:67], v[46:47], v[64:65] op_sel:[1,1,0] op_sel_hi:[1,0,1] neg_lo:[0,1,0]
    v_pk_fma_f32 v[40:41], v[60:61], v[30:31], v[40:41] op_sel:[1,1,0] op_sel_hi:[1,0,1] neg_lo:[0,1,0]
    v_pk_mul_f32 v[66:67], v[64:65], v[46:47] op_sel:[0,0] op_sel_hi:[0,1]
    v_pk_mul_f32 v[20:21], v[18:19], v[16:17] op_sel:[0,0] op_sel_hi:[0,1]
    v_cvt_pk_bf16_f32 v70, v64, v65
    ds_write_addtid_b32 v70 offset:1360
    v_pk_fma_f32 v[66:67], v[64:65], v[46:47], v[66:67] op_sel:[1,1,0] op_sel_hi:[1,0,1] neg_lo:[0,1,0]
    v_pk_fma_f32 v[20:21], v[18:19], v[16:17], v[20:21] op_sel:[1,1,0] op_sel_hi:[1,0,1] neg_lo:[0,1,0]
    v_cvt_pk_bf16_f32 v71, v66, v67
    ds_write_addtid_b32 v71 offset:3536
    ds_read_b128 v[72:75], v116 offset:0
    ds_read_b128 v[76:79], v116 offset:16
    ds_read_b128 v[80:83], v116 offset:32
    ds_read_b128 v[84:87], v116 offset:48
    v_pk_mul_f32 v[24:25], v[22:23], v[16:17] op_sel:[0,0] op_sel_hi:[0,1]
    v_cvt_pk_bf16_f32 v68, v54, v55
    ds_write_addtid_b32 v68 offset:1632
    v_pk_fma_f32 v[24:25], v[22:23], v[16:17], v[24:25] op_sel:[1,1,0] op_sel_hi:[1,0,1] neg_lo:[0,1,0]
    v_pk_mul_f32 v[26:27], v[22:23], v[18:19] op_sel:[0,0] op_sel_hi:[0,1]
    v_cvt_pk_bf16_f32 v69, v56, v57
    ds_write_addtid_b32 v69 offset:0
    v_pk_fma_f32 v[26:27], v[22:23], v[18:19], v[26:27] op_sel:[1,1,0] op_sel_hi:[1,0,1] neg_lo:[0,1,0]
    v_pk_mul_f32 v[28:29], v[22:23], v[20:21] op_sel:[0,0] op_sel_hi:[0,1]
    v_cvt_pk_bf16_f32 v70, v58, v59
    ds_write_addtid_b32 v70 offset:544
    v_pk_fma_f32 v[28:29], v[22:23], v[20:21], v[28:29] op_sel:[1,1,0] op_sel_hi:[1,0,1] neg_lo:[0,1,0]
    v_pk_mul_f32 v[38:39], v[30:31], v[22:23] op_sel:[0,0] op_sel_hi:[0,1]
    v_cvt_pk_bf16_f32 v71, v60, v61
    ds_write_addtid_b32 v71 offset:1088
    v_pk_fma_f32 v[38:39], v[30:31], v[22:23], v[38:39] op_sel:[1,1,0] op_sel_hi:[1,0,1] neg_lo:[0,1,0]
    v_cvt_pk_bf16_f32 v68, v62, v63
    ds_write_addtid_b32 v68 offset:4080
    v_cvt_pk_bf16_f32 v69, v32, v33
    ds_write_addtid_b32 v69 offset:3808
    v_cvt_pk_bf16_f32 v70, v34, v35
    ds_write_addtid_b32 v70 offset:2176
    v_cvt_pk_bf16_f32 v71, v36, v37
    ds_write_addtid_b32 v71 offset:2720
    v_cvt_pk_bf16_f32 v68, v40, v41
    ds_write_addtid_b32 v68 offset:3264
    ds_read_b128 v[88:91], v116 offset:0
    ds_read_b128 v[92:95], v116 offset:16
    ds_read_b128 v[96:99], v116 offset:32
    ds_read_b128 v[100:103], v116 offset:48
    v_pk_mul_f32 v[42:43], v[30:31], v[26:27] op_sel:[0,0] op_sel_hi:[0,1]
    v_pk_mul_f32 v[44:45], v[30:31], v[28:29] op_sel:[0,0] op_sel_hi:[0,1]
    v_pk_mul_f32 v[32:33], v[30:31], v[16:17] op_sel:[0,0] op_sel_hi:[0,1]
    v_pk_mul_f32 v[34:35], v[30:31], v[18:19] op_sel:[0,0] op_sel_hi:[0,1]
    v_pk_fma_f32 v[42:43], v[30:31], v[26:27], v[42:43] op_sel:[1,1,0] op_sel_hi:[1,0,1] neg_lo:[0,1,0]
    v_pk_fma_f32 v[44:45], v[30:31], v[28:29], v[44:45] op_sel:[1,1,0] op_sel_hi:[1,0,1] neg_lo:[0,1,0]
    v_pk_fma_f32 v[32:33], v[30:31], v[16:17], v[32:33] op_sel:[1,1,0] op_sel_hi:[1,0,1] neg_lo:[0,1,0]
    v_pk_fma_f32 v[34:35], v[30:31], v[18:19], v[34:35] op_sel:[1,1,0] op_sel_hi:[1,0,1] neg_lo:[0,1,0]
    v_pk_mul_f32 v[36:37], v[30:31], v[20:21] op_sel:[0,0] op_sel_hi:[0,1]
    v_pk_mul_f32 v[40:41], v[30:31], v[24:25] op_sel:[0,0] op_sel_hi:[0,1]
    s_waitcnt lgkmcnt(0)
    v_mfma_f32_16x16x32_bf16 v[112:115], v[88:91], v[72:75], 0
    v_mfma_f32_16x16x32_bf16 v[112:115], v[92:95], v[76:79], v[112:115]
    v_mfma_f32_16x16x32_bf16 v[112:115], v[96:99], v[80:83], v[112:115]
    v_mfma_f32_16x16x32_bf16 v[112:115], v[100:103], v[84:87], v[112:115]
    v_pk_fma_f32 v[36:37], v[30:31], v[20:21], v[36:37] op_sel:[1,1,0] op_sel_hi:[1,0,1] neg_lo:[0,1,0]
    v_pk_fma_f32 v[40:41], v[30:31], v[24:25], v[40:41] op_sel:[1,1,0] op_sel_hi:[1,0,1] neg_lo:[0,1,0]
    v_mov_b32 v69, 0x3f80
    ds_write_addtid_b32 v69 offset:1632
    v_cvt_pk_bf16_f32 v70, v16, v17
    ds_write_addtid_b32 v70 offset:3808
    v_cvt_pk_bf16_f32 v71, v18, v19
    ds_write_addtid_b32 v71 offset:1904
    v_cvt_pk_bf16_f32 v68, v20, v21
    ds_write_addtid_b32 v68 offset:4080
    v_cvt_pk_bf16_f32 v69, v22, v23
    ds_write_addtid_b32 v69 offset:0
    ds_write_b128 v117, v[112:115]
    s_mov_b64 exec, 1
    ds_add_u32 v125, v126 offset:0
    s_mov_b64 exec, -1
    s_setprio 2
    v_cvt_pk_bf16_f32 v70, v24, v25
    ds_write_addtid_b32 v70 offset:2176
    v_cvt_pk_bf16_f32 v71, v26, v27
    ds_write_addtid_b32 v71 offset:272
    v_cvt_pk_bf16_f32 v68, v28, v29
    ds_write_addtid_b32 v68 offset:2448
    v_cvt_pk_bf16_f32 v69, v30, v31
    ds_write_addtid_b32 v69 offset:544
    v_cvt_pk_bf16_f32 v70, v32, v33
    ds_write_addtid_b32 v70 offset:2720
    v_cvt_pk_bf16_f32 v71, v34, v35
    ds_write_addtid_b32 v71 offset:816
    v_cvt_pk_bf16_f32 v68, v36, v37
    ds_write_addtid_b32 v68 offset:2992
    v_cvt_pk_bf16_f32 v69, v38, v39
    ds_write_addtid_b32 v69 offset:1088
    v_cvt_pk_bf16_f32 v70, v40, v41
    ds_write_addtid_b32 v70 offset:3264
    v_cvt_pk_bf16_f32 v71, v42, v43
    ds_write_addtid_b32 v71 offset:1360
    v_cvt_pk_bf16_f32 v68, v44, v45
    ds_write_addtid_b32 v68 offset:3536
    ds_read_b128 v[88:91], v116 offset:0
    ds_read_b128 v[92:95], v116 offset:16
    ds_read_b128 v[96:99], v116 offset:32
    ds_read_b128 v[100:103], v116 offset:48
    v_pk_mul_f32 v[56:57], v[48:49], v[18:19] op_sel:[0,0] op_sel_hi:[0,1]
    v_pk_fma_f32 v[56:57], v[48:49], v[18:19], v[56:57] op_sel:[1,1,0] op_sel_hi:[1,0,1] neg_lo:[0,1,0]
    v_pk_mul_f32 v[58:59], v[48:49], v[22:23] op_sel:[0,0] op_sel_hi:[0,1]
    v_pk_fma_f32 v[58:59], v[48:49], v[22:23], v[58:59] op_sel:[1,1,0] op_sel_hi:[1,0,1] neg_lo:[0,1,0]
    v_pk_mul_f32 v[60:61], v[48:49], v[26:27] op_sel:[0,0] op_sel_hi:[0,1]
    s_waitcnt lgkmcnt(0)
    v_mfma_f32_16x16x32_bf16 v[104:107], v[88:91], v[72:75], 0
    v_mfma_f32_16x16x32_bf16 v[104:107], v[92:95], v[76:79], v[104:107]
    v_mfma_f32_16x16x32_bf16 v[104:107], v[96:99], v[80:83], v[104:107]
    v_mfma_f32_16x16x32_bf16 v[104:107], v[100:103], v[84:87], v[104:107]
    v_cvt_pk_bf16_f32 v69, v56, v57
    ds_write_addtid_b32 v69 offset:3808
    v_cvt_pk_bf16_f32 v70, v58, v59
    ds_write_addtid_b32 v70 offset:1904
    v_pk_fma_f32 v[60:61], v[48:49], v[26:27], v[60:61] op_sel:[1,1,0] op_sel_hi:[1,0,1] neg_lo:[0,1,0]
    v_pk_mul_f32 v[62:63], v[48:49], v[30:31] op_sel:[0,0] op_sel_hi:[0,1]
    v_cvt_pk_bf16_f32 v71, v60, v61
    ds_write_addtid_b32 v71 offset:4080
    v_pk_fma_f32 v[62:63], v[48:49], v[30:31], v[62:63] op_sel:[1,1,0] op_sel_hi:[1,0,1] neg_lo:[0,1,0]
    v_pk_mul_f32 v[56:57], v[48:49], v[34:35] op_sel:[0,0] op_sel_hi:[0,1]
    v_cvt_pk_bf16_f32 v68, v62, v63
    ds_write_addtid_b32 v68 offset:0
    v_pk_fma_f32 v[56:57], v[48:49], v[34:35], v[56:57] op_sel:[1,1,0] op_sel_hi:[1,0,1] neg_lo:[0,1,0]
    v_pk_mul_f32 v[58:59], v[48:49], v[38:39] op_sel:[0,0] op_sel_hi:[0,1]
    v_cvt_pk_bf16_f32 v69, v56, v57
    ds_write_addtid_b32 v69 offset:2176
    v_pk_fma_f32 v[58:59], v[48:49], v[38:39], v[58:59] op_sel:[1,1,0] op_sel_hi:[1,0,1] neg_lo:[0,1,0]
    v_add_u32 v15, s44, v118
    s_cmp_eq_u32 s6, 1
    s_cbranch_scc1 L_nopub1
    ds_write_b128 v15, v[104:107]
    s_mov_b64 exec, 1
    ds_add_u32 v125, v126 offset:4
    s_mov_b64 exec, -1
L_nopub1:
    s_setprio 1
    v_pk_mul_f32 v[60:61], v[48:49], v[42:43] op_sel:[0,0] op_sel_hi:[0,1]
    v_cvt_pk_bf16_f32 v70, v58, v59
    ds_write_addtid_b32 v70 offset:272
    v_pk_fma_f32 v[60:61], v[48:49], v[42:43], v[60:61] op_sel:[1,1,0] op_sel_hi:[1,0,1] neg_lo:[0,1,0]
    v_pk_mul_f32 v[62:63], v[50:51], v[22:23] op_sel:[0,0] op_sel_hi:[0,1]
    v_cvt_pk_bf16_f32 v71, v60, v61
    ds_write_addtid_b32 v71 offset:2448
    v_pk_fma_f32 v[62:63], v[50:51], v[22:23], v[62:63] op_sel:[1,1,0] op_sel_hi:[1,0,1] neg_lo:[0,1,0]
    v_pk_mul_f32 v[56:57], v[50:51], v[30:31] op_sel:[0,0] op_sel_hi:[0,1]
    v_cvt_pk_bf16_f32 v68, v62, v63
    ds_write_addtid_b32 v68 offset:2720
    v_pk_fma_f32 v[56:57], v[50:51], v[30:31], v[56:57] op_sel:[1,1,0] op_sel_hi:[1,0,1] neg_lo:[0,1,0]
    v_pk_mul_f32 v[58:59], v[50:51], v[38:39] op_sel:[0,0] op_sel_hi:[0,1]
    v_cvt_pk_bf16_f32 v69, v56, v57
    ds_write_addtid_b32 v69 offset:816
    v_pk_fma_f32 v[58:59], v[50:51], v[38:39], v[58:59] op_sel:[1,1,0] op_sel_hi:[1,0,1] neg_lo:[0,1,0]
    v_pk_mul_f32 v[60:61], v[52:53], v[22:23] op_sel:[0,0] op_sel_hi:[0,1]
    v_cvt_pk_bf16_f32 v70, v58, v59
    ds_write_addtid_b32 v70 offset:2992
    v_pk_fma_f32 v[60:61], v[52:53], v[22:23], v[60:61] op_sel:[1,1,0] op_sel_hi:[1,0,1] neg_lo:[0,1,0]
    v_pk_mul_f32 v[62:63], v[52:53], v[30:31] op_sel:[0,0] op_sel_hi:[0,1]
    v_cvt_pk_bf16_f32 v71, v60, v61
    ds_write_addtid_b32 v71 offset:3264
    v_pk_fma_f32 v[62:63], v[52:53], v[30:31], v[62:63] op_sel:[1,1,0] op_sel_hi:[1,0,1] neg_lo:[0,1,0]
    v_pk_mul_f32 v[56:57], v[52:53], v[38:39] op_sel:[0,0] op_sel_hi:[0,1]
    v_cvt_pk_bf16_f32 v68, v62, v63
    ds_write_addtid_b32 v68 offset:1360
    v_pk_fma_f32 v[56:57], v[52:53], v[38:39], v[56:57] op_sel:[1,1,0] op_sel_hi:[1,0,1] neg_lo:[0,1,0]
    v_cvt_pk_bf16_f32 v69, v56, v57
    ds_write_addtid_b32 v69 offset:3536
    v_cvt_pk_bf16_f32 v70, v48, v49
    ds_write_addtid_b32 v70 offset:1632
    v_cvt_pk_bf16_f32 v71, v50, v51
    ds_write_addtid_b32 v71 offset:544
    v_cvt_pk_bf16_f32 v68, v52, v53
    ds_write_addtid_b32 v68 offset:1088
    ds_read_b128 v[88:91], v116 offset:0
    ds_read_b128 v[92:95], v116 offset:16
    ds_read_b128 v[96:99], v116 offset:32
    ds_read_b128 v[100:103], v116 offset:48
    v_add_u32 v2, s11, v118
    s_mul_i32 s12, s5, 4352
    v_and_b32 v4, 15, v0
    v_lshrrev_b32 v5, 4, v0
    s_waitcnt lgkmcnt(0)
    v_mfma_f32_16x16x32_bf16 v[108:111], v[88:91], v[72:75], 0
    v_mfma_f32_16x16x32_bf16 v[108:111], v[92:95], v[76:79], v[108:111]
    v_mfma_f32_16x16x32_bf16 v[108:111], v[96:99], v[80:83], v[108:111]
    v_mfma_f32_16x16x32_bf16 v[108:111], v[100:103], v[84:87], v[108:111]
    v_add_u32 v116, s12, v118
    v_add_u32 v117, s14, v118
    s_lshl_b32 s13, s5, 11
    s_add_u32 s13, s13, 152224
    v_add_u32 v15, s13, v118
    s_nop 2
    ds_write_b128 v2, v[108:111]
    s_cmp_eq_u32 s6, 2
    s_cbranch_scc1 L_fin1
    s_mov_b64 exec, 1
    ds_add_u32 v125, v126 offset:8
    s_mov_b64 exec, -1
    s_cmp_eq_u32 s6, 0
    s_cbranch_scc1 L_fin2
    s_setprio 3
L_bp2:
    ds_read_b32 v124, v125 offset:4
    ds_read_b128 v[32:35], v15
    ds_read_b128 v[36:39], v15 offset:1024
    s_waitcnt lgkmcnt(2)
    v_readfirstlane_b32 s46, v124
    s_cmp_lt_u32 s46, 2
    s_cbranch_scc1 L_bps4
    s_branch L_bpd3
L_bps4:
    s_sleep 1
    s_waitcnt lgkmcnt(0)
    s_branch L_bp2
L_bpd3:
    s_waitcnt lgkmcnt(0)
    v_pk_add_f32 v[32:33], v[32:33], v[36:37]
    v_pk_add_f32 v[34:35], v[34:35], v[38:39]
    v_pk_add_f32 v[104:105], v[104:105], v[32:33]
    v_pk_add_f32 v[106:107], v[106:107], v[34:35]
    v_cvt_pk_bf16_f32 v32, v107, v106
    v_cvt_pk_bf16_f32 v33, v105, v104
    ds_write_b64 v119, v[32:33]
    ds_write_b64 v119, v[32:33] offset:4232
    s_mov_b64 exec, 1
    ds_add_u32 v125, v126 offset:16
    s_mov_b64 exec, -1
    s_setprio 0
    v_and_b32 v10, 1, v4
    v_mul_u32_u24 v10, 4224, v10
    v_lshrrev_b32 v7, 1, v4
    v_sub_u32 v7, v5, v7
    v_lshl_add_u32 v10, v7, 4, v10
    s_add_u32 s15, s14, 576
    v_add_u32 v12, s15, v10
    v_and_b32 v10, 3, v4
    v_lshrrev_b32 v7, 2, v4
    v_mul_u32_u24 v3, 4128, v10
    s_mul_i32 s15, s5, 16512
    s_add_u32 s15, s15, 86016
    v_add_u32 v3, s15, v3
    v_lshl_add_u32 v8, v7, 3, v5
    v_lshl_add_u32 v13, v8, 4, v3
    v_add_u32 v13, 80, v13
    v_lshl_add_u32 v8, v7, 2, v5
    v_lshlrev_b32 v8, 5, v8
    v_lshl_add_u32 v8, v10, 2, v8
    v_add_u32 v8, s12, v8
    v_mov_b32 v9, 152192
    v_mov_b32 v16, 0
    v_mov_b32 v17, 0
    v_mov_b32 v18, 0
    v_mov_b32 v19, 0
    v_mov_b32 v20, 0
    v_mov_b32 v21, 0
    v_mov_b32 v22, 0
    v_mov_b32 v23, 0
    v_mov_b32 v24, 0
    v_mov_b32 v25, 0
    v_mov_b32 v26, 0
    v_mov_b32 v27, 0
    v_mov_b32 v28, 0
    v_mov_b32 v29, 0
    v_mov_b32 v30, 0
    v_mov_b32 v31, 0
    s_waitcnt vmcnt(0)
L_bp5:
    ds_read_b32 v124, v125 offset:20
    ds_read_b32 v60, v9 offset:8
    s_waitcnt lgkmcnt(0)
    v_readfirstlane_b32 s46, v124
    v_readfirstlane_b32 s47, v60
    s_cmp_lt_u32 s46, 1
    s_cbranch_scc1 L_bps7
    s_cmp_lt_u32 s47, 2
    s_cbranch_scc1 L_bps7
    s_branch L_bpd6
L_bps7:
    s_sleep 1
    s_waitcnt lgkmcnt(0)
    s_branch L_bp5
L_bpd6:
    s_setprio 2
    v_subrev_u32 v1, 448, v12
    v_subrev_u32 v2, 448, v13
    ds_read_b128 v[32:35], v1 offset:4032
    ds_read_b128 v[36:39], v2 offset:448
    ds_read_b128 v[40:43], v2 offset:960
    ds_read_b128 v[44:47], v2 offset:1472
    ds_read_b128 v[48:51], v2 offset:1984
    ds_read_b128 v[52:55], v1 offset:3520
    ds_read_b128 v[56:59], v1 offset:3008
    ds_read_b128 v[60:63], v1 offset:2496
    ds_read_b128 v[64:67], v1 offset:3968
    ds_read_b128 v[68:71], v2 offset:384
    ds_read_b128 v[72:75], v2 offset:896
    ds_read_b128 v[76:79], v2 offset:1408
    ds_read_b128 v[80:83], v2 offset:1920
    ds_read_b128 v[84:87], v1 offset:3456
    s_waitcnt lgkmcnt(9)
    v_mfma_f32_16x16x32_bf16 v[16:19], v[32:35], v[36:39], v[16:19]
    ds_read_b128 v[88:91], v1 offset:2944
    v_mfma_f32_16x16x32_bf16 v[20:23], v[32:35], v[40:43], v[20:23]
    v_mfma_f32_16x16x32_bf16 v[24:27], v[32:35], v[44:47], v[24:27]
    ds_read_b128 v[92:95], v1 offset:2432
    v_mfma_f32_16x16x32_bf16 v[28:31], v[32:35], v[48:51], v[28:31]
    ds_read_b128 v[96:99], v1 offset:3904
    s_waitcnt lgkmcnt(10)
    v_mfma_f32_16x16x32_bf16 v[20:23], v[52:55], v[36:39], v[20:23]
    v_subrev_u32 v11, 128, v13
    v_max_i32 v11, v11, v3
    ds_read_b128 v[100:103], v11
    v_mfma_f32_16x16x32_bf16 v[24:27], v[52:55], v[40:43], v[24:27]
    ds_read_b128 v[104:107], v2 offset:832
    v_mfma_f32_16x16x32_bf16 v[28:31], v[52:55], v[44:47], v[28:31]
    ds_read_b128 v[108:111], v2 offset:1344
    v_mfma_f32_16x16x32_bf16 v[24:27], v[56:59], v[36:39], v[24:27]
    ds_read_b128 v[112:115], v2 offset:1856
    v_mfma_f32_16x16x32_bf16 v[28:31], v[56:59], v[40:43], v[28:31]
    ds_read_b128 v[116:119], v1 offset:3392
    s_waitcnt lgkmcnt(10)
    v_mfma_f32_16x16x32_bf16 v[28:31], v[60:63], v[36:39], v[28:31]
    v_mfma_f32_16x16x32_bf16 v[16:19], v[64:67], v[68:71], v[16:19]
    ds_read_b128 v[120:123], v1 offset:2880
    v_mfma_f32_16x16x32_bf16 v[20:23], v[64:67], v[72:75], v[20:23]
    v_mfma_f32_16x16x32_bf16 v[24:27], v[64:67], v[76:79], v[24:27]
    ds_read_b128 v[32:35], v1 offset:2368
    s_waitcnt lgkmcnt(10)
    v_mfma_f32_16x16x32_bf16 v[28:31], v[64:67], v[80:83], v[28:31]
    ds_read_b128 v[48:51], v1 offset:3840
    v_mfma_f32_16x16x32_bf16 v[20:23], v[84:87], v[68:71], v[20:23]
    v_subrev_u32 v10, 192, v13
    v_max_i32 v10, v10, v3
    ds_read_b128 v[52:55], v10
    v_mfma_f32_16x16x32_bf16 v[24:27], v[84:87], v[72:75], v[24:27]
    ds_read_b128 v[44:47], v2 offset:768
    v_mfma_f32_16x16x32_bf16 v[28:31], v[84:87], v[76:79], v[28:31]
    ds_read_b128 v[56:59], v2 offset:1280
    s_waitcnt lgkmcnt(10)
    v_mfma_f32_16x16x32_bf16 v[24:27], v[88:91], v[68:71], v[24:27]
    ds_read_b128 v[40:43], v2 offset:1792
    v_mfma_f32_16x16x32_bf16 v[28:31], v[88:91], v[72:75], v[28:31]
    ds_read_b128 v[60:63], v1 offset:3328
    v_mfma_f32_16x16x32_bf16 v[28:31], v[92:95], v[68:71], v[28:31]
    v_mfma_f32_16x16x32_bf16 v[16:19], v[96:99], v[100:103], v[16:19]
    ds_read_b128 v[36:39], v1 offset:2816
    s_waitcnt lgkmcnt(9)
    v_mfma_f32_16x16x32_bf16 v[20:23], v[96:99], v[104:107], v[20:23]
    v_mfma_f32_16x16x32_bf16 v[24:27], v[96:99], v[108:111], v[24:27]
    ds_read_b128 v[64:67], v1 offset:2304
    v_mfma_f32_16x16x32_bf16 v[28:31], v[96:99], v[112:115], v[28:31]
    ds_read_b128 v[80:83], v1 offset:3776
    v_mfma_f32_16x16x32_bf16 v[20:23], v[116:119], v[100:103], v[20:23]
    v_subrev_u32 v11, 256, v13
    v_max_i32 v11, v11, v3
    ds_read_b128 v[84:87], v11
    v_mfma_f32_16x16x32_bf16 v[24:27], v[116:119], v[104:107], v[24:27]
    ds_read_b128 v[76:79], v2 offset:704
    v_mfma_f32_16x16x32_bf16 v[28:31], v[116:119], v[108:111], v[28:31]
    ds_read_b128 v[88:91], v2 offset:1216
    s_waitcnt lgkmcnt(10)
    v_mfma_f32_16x16x32_bf16 v[24:27], v[120:123], v[100:103], v[24:27]
    ds_read_b128 v[72:75], v2 offset:1728
    v_mfma_f32_16x16x32_bf16 v[28:31], v[120:123], v[104:107], v[28:31]
    ds_read_b128 v[92:95], v1 offset:3264
    v_mfma_f32_16x16x32_bf16 v[28:31], v[32:35], v[100:103], v[28:31]
    v_mfma_f32_16x16x32_bf16 v[16:19], v[48:51], v[52:55], v[16:19]
    ds_read_b128 v[68:71], v1 offset:2752
    s_waitcnt lgkmcnt(9)
    v_mfma_f32_16x16x32_bf16 v[20:23], v[48:51], v[44:47], v[20:23]
    v_mfma_f32_16x16x32_bf16 v[24:27], v[48:51], v[56:59], v[24:27]
    ds_read_b128 v[96:99], v1 offset:2240
    v_mfma_f32_16x16x32_bf16 v[28:31], v[48:51], v[40:43], v[28:31]
    ds_read_b128 v[112:115], v1 offset:3712
    v_mfma_f32_16x16x32_bf16 v[20:23], v[60:63], v[52:55], v[20:23]
    v_subrev_u32 v10, 320, v13
    v_max_i32 v10, v10, v3
    ds_read_b128 v[116:119], v10
    v_mfma_f32_16x16x32_bf16 v[24:27], v[60:63], v[44:47], v[24:27]
    ds_read_b128 v[108:111], v2 offset:640
    v_mfma_f32_16x16x32_bf16 v[28:31], v[60:63], v[56:59], v[28:31]
    ds_read_b128 v[120:123], v2 offset:1152
    s_waitcnt lgkmcnt(10)
    v_mfma_f32_16x16x32_bf16 v[24:27], v[36:39], v[52:55], v[24:27]
    ds_read_b128 v[104:107], v2 offset:1664
    v_mfma_f32_16x16x32_bf16 v[28:31], v[36:39], v[44:47], v[28:31]
    ds_read_b128 v[32:35], v1 offset:3200
    v_mfma_f32_16x16x32_bf16 v[28:31], v[64:67], v[52:55], v[28:31]
    v_mfma_f32_16x16x32_bf16 v[16:19], v[80:83], v[84:87], v[16:19]
    ds_read_b128 v[100:103], v1 offset:2688
    s_waitcnt lgkmcnt(9)
    v_mfma_f32_16x16x32_bf16 v[20:23], v[80:83], v[76:79], v[20:23]
    v_mfma_f32_16x16x32_bf16 v[24:27], v[80:83], v[88:91], v[24:27]
    ds_read_b128 v[48:51], v1 offset:2176
    v_mfma_f32_16x16x32_bf16 v[28:31], v[80:83], v[72:75], v[28:31]
    ds_read_b128 v[40:43], v1 offset:3648
    v_mfma_f32_16x16x32_bf16 v[20:23], v[92:95], v[84:87], v[20:23]
    v_subrev_u32 v11, 384, v13
    v_max_i32 v11, v11, v3
    ds_read_b128 v[60:63], v11
    v_mfma_f32_16x16x32_bf16 v[24:27], v[92:95], v[76:79], v[24:27]
    ds_read_b128 v[56:59], v2 offset:576
    v_mfma_f32_16x16x32_bf16 v[28:31], v[92:95], v[88:91], v[28:31]
    ds_read_b128 v[36:39], v2 offset:1088
    s_waitcnt lgkmcnt(10)
    v_mfma_f32_16x16x32_bf16 v[24:27], v[68:71], v[84:87], v[24:27]
    ds_read_b128 v[44:47], v2 offset:1600
    v_mfma_f32_16x16x32_bf16 v[28:31], v[68:71], v[76:79], v[28:31]
    ds_read_b128 v[64:67], v1 offset:3136
    v_mfma_f32_16x16x32_bf16 v[28:31], v[96:99], v[84:87], v[28:31]
    v_mfma_f32_16x16x32_bf16 v[16:19], v[112:115], v[116:119], v[16:19]
    ds_read_b128 v[52:55], v1 offset:2624
    s_waitcnt lgkmcnt(9)
    v_mfma_f32_16x16x32_bf16 v[20:23], v[112:115], v[108:111], v[20:23]
    v_mfma_f32_16x16x32_bf16 v[24:27], v[112:115], v[120:123], v[24:27]
    ds_read_b128 v[80:83], v1 offset:2112
    v_mfma_f32_16x16x32_bf16 v[28:31], v[112:115], v[104:107], v[28:31]
    ds_read_b128 v[72:75], v1 offset:3584
    v_mfma_f32_16x16x32_bf16 v[20:23], v[32:35], v[116:119], v[20:23]
    v_subrev_u32 v10, 448, v13
    v_max_i32 v10, v10, v3
    ds_read_b128 v[92:95], v10
    v_mfma_f32_16x16x32_bf16 v[24:27], v[32:35], v[108:111], v[24:27]
    ds_read_b128 v[88:91], v2 offset:512
    v_mfma_f32_16x16x32_bf16 v[28:31], v[32:35], v[120:123], v[28:31]
    ds_read_b128 v[68:71], v2 offset:1024
    s_waitcnt lgkmcnt(10)
    v_mfma_f32_16x16x32_bf16 v[24:27], v[100:103], v[116:119], v[24:27]
    ds_read_b128 v[76:79], v2 offset:1536
    v_mfma_f32_16x16x32_bf16 v[28:31], v[100:103], v[108:111], v[28:31]
    ds_read_b128 v[96:99], v1 offset:3072
    v_mfma_f32_16x16x32_bf16 v[28:31], v[48:51], v[116:119], v[28:31]
    v_mfma_f32_16x16x32_bf16 v[16:19], v[40:43], v[60:63], v[16:19]
    ds_read_b128 v[84:87], v1 offset:2560
    s_waitcnt lgkmcnt(9)
    v_mfma_f32_16x16x32_bf16 v[20:23], v[40:43], v[56:59], v[20:23]
    v_mfma_f32_16x16x32_bf16 v[24:27], v[40:43], v[36:39], v[24:27]
    ds_read_b128 v[112:115], v1 offset:2048
    v_mfma_f32_16x16x32_bf16 v[28:31], v[40:43], v[44:47], v[28:31]
    v_mfma_f32_16x16x32_bf16 v[20:23], v[64:67], v[60:63], v[20:23]
    v_mfma_f32_16x16x32_bf16 v[24:27], v[64:67], v[56:59], v[24:27]
    v_mfma_f32_16x16x32_bf16 v[28:31], v[64:67], v[36:39], v[28:31]
    s_waitcnt lgkmcnt(6)
    v_mfma_f32_16x16x32_bf16 v[24:27], v[52:55], v[60:63], v[24:27]
    v_mfma_f32_16x16x32_bf16 v[28:31], v[52:55], v[56:59], v[28:31]
    v_mfma_f32_16x16x32_bf16 v[28:31], v[80:83], v[60:63], v[28:31]
    v_mfma_f32_16x16x32_bf16 v[16:19], v[72:75], v[92:95], v[16:19]
    s_waitcnt lgkmcnt(2)
    v_mfma_f32_16x16x32_bf16 v[20:23], v[72:75], v[88:91], v[20:23]
    v_mfma_f32_16x16x32_bf16 v[24:27], v[72:75], v[68:71], v[24:27]
    v_mfma_f32_16x16x32_bf16 v[28:31], v[72:75], v[76:79], v[28:31]
    v_mfma_f32_16x16x32_bf16 v[20:23], v[96:99], v[92:95], v[20:23]
    v_mfma_f32_16x16x32_bf16 v[24:27], v[96:99], v[88:91], v[24:27]
    v_mfma_f32_16x16x32_bf16 v[28:31], v[96:99], v[68:71], v[28:31]
    s_waitcnt lgkmcnt(0)
    v_mfma_f32_16x16x32_bf16 v[24:27], v[84:87], v[92:95], v[24:27]
    v_mfma_f32_16x16x32_bf16 v[28:31], v[84:87], v[88:91], v[28:31]
    v_mfma_f32_16x16x32_bf16 v[28:31], v[112:115], v[92:95], v[28:31]
    v_cvt_pk_bf16_f32 v16, v16, v17
    v_cvt_pk_bf16_f32 v18, v18, v19
    ds_write_b32 v8, v16 offset:0
    ds_write_b32 v8, v18 offset:16
    v_cvt_pk_bf16_f32 v20, v20, v21
    v_cvt_pk_bf16_f32 v22, v22, v23
    ds_write_b32 v8, v20 offset:512
    ds_write_b32 v8, v22 offset:528
    v_cvt_pk_bf16_f32 v24, v24, v25
    v_cvt_pk_bf16_f32 v26, v26, v27
    ds_write_b32 v8, v24 offset:1024
    ds_write_b32 v8, v26 offset:1040
    v_cvt_pk_bf16_f32 v28, v28, v29
    v_cvt_pk_bf16_f32 v30, v30, v31
    ds_write_b32 v8, v28 offset:1536
    ds_write_b32 v8, v30 offset:1552
    s_mov_b64 exec, 1
    ds_add_u32 v9, v126 offset:16
    s_mov_b64 exec, -1
    s_endpgm
L_fin1:
    s_setprio 3
L_bp8:
    ds_read_b32 v60, v125 offset:8
    ds_read_b64 v[76:77], v125 offset:24
    ds_read_b128 v[32:35], v116
    ds_read_b128 v[36:39], v116 offset:17408
    ds_read_b128 v[64:67], v127
    ds_read_b128 v[68:71], v127 offset:17408
    ds_read_b128 v[72:75], v127 offset:34816
    s_waitcnt lgkmcnt(5)
    v_readfirstlane_b32 s46, v60
    v_readfirstlane_b32 s47, v76
    s_cmp_lt_u32 s46, 2
    s_cbranch_scc1 L_bps10
    s_cmp_lt_u32 s47, 1
    s_cbranch_scc1 L_bps10
    s_branch L_bpd9
L_bps10:
    s_sleep 0
    s_waitcnt lgkmcnt(0)
    s_branch L_bp8
L_bpd9:
    s_waitcnt lgkmcnt(3)
    v_pk_add_f32 v[32:33], v[32:33], v[36:37]
    v_pk_add_f32 v[34:35], v[34:35], v[38:39]
    v_pk_add_f32 v[108:109], v[108:109], v[32:33]
    v_pk_add_f32 v[110:111], v[110:111], v[34:35]
    v_cvt_pk_bf16_f32 v43, v111, v111
    v_cvt_pk_bf16_f32 v44, v111, v110
    v_cvt_pk_bf16_f32 v45, v110, v110
    v_cvt_pk_bf16_f32 v47, v109, v109
    v_cvt_pk_bf16_f32 v48, v109, v108
    v_cvt_pk_bf16_f32 v49, v108, v108
    v_cvt_pk_bf16_f32 v56, v110, v109
    v_mov_b32 v46, v45
    v_mov_b32 v55, v45
    v_mov_b32 v57, v49
    s_mov_b32 exec_lo, 0
    ds_write_b128 v119, v[44:47] offset:16
    ds_write_b128 v119, v[46:49] offset:4256
    s_mov_b64 exec, -1
    v_cmp_eq_u32 vcc, 63, v0
    s_or_b64 s[44:45], s[42:43], vcc
    s_waitcnt lgkmcnt(2)
    v_pk_add_f32 v[64:65], v[64:65], v[68:69]
    v_pk_add_f32 v[66:67], v[66:67], v[70:71]
    v_pk_add_f32 v[72:73], v[72:73], v[64:65]
    v_pk_add_f32 v[74:75], v[74:75], v[66:67]
    v_cndmask_b32 v72, v72, v77, vcc
    v_cndmask_b32 v74, v74, v73, s[42:43]
    v_cndmask_b32 v73, v73, v72, s[44:45]
    v_cvt_pk_bf16_f32 v40, v73, v72
    v_cvt_pk_bf16_f32 v41, v72, v72
    v_cvt_pk_bf16_f32 v52, v74, v73
    v_cvt_pk_bf16_f32 v54, v72, v111
    v_mov_b32 v42, v41
    v_mov_b32 v53, v41
    s_mov_b32 exec_lo, 0
    ds_write_b128 v119, v[40:43]
    ds_write_b128 v119, v[42:45] offset:4240
    s_mov_b32 exec_lo, -1
    s_mov_b32 exec_hi, 0
    ds_write_b128 v119, v[52:55] offset:16
    ds_write_b128 v119, v[54:57] offset:4256
    s_mov_b64 exec, 1
    ds_write_b64 v119, v[56:57] offset:32
    s_mov_b64 exec, -1
    s_mov_b64 exec, 1
    ds_add_u32 v125, v126 offset:20
    s_mov_b64 exec, -1
    s_endpgm
L_fin2:
    s_setprio 3
L_bp11:
    ds_read_b32 v124, v125 offset:0
    ds_read_b64 v[32:33], v117
    ds_read_b64 v[34:35], v117 offset:4240
    ds_read_b32 v36, v127
    ds_read_b32 v37, v127 offset:1024
    ds_read_b32 v38, v127 offset:4240
    s_waitcnt lgkmcnt(5)
    v_readfirstlane_b32 s46, v124
    s_cmp_lt_u32 s46, 3
    s_cbranch_scc1 L_bps13
    s_branch L_bpd12
L_bps13:
    s_sleep 1
    s_waitcnt lgkmcnt(0)
    s_branch L_bp11
L_bpd12:
    s_waitcnt lgkmcnt(0)
    v_pk_add_f32 v[32:33], v[32:33], v[34:35]
    v_pk_add_f32 v[112:113], v[112:113], v[32:33]
    s_mov_b64 exec, 1
    ds_write_b32 v125, v112 offset:28
    ds_add_u32 v125, v126 offset:24
    s_mov_b64 exec, -1
    v_cvt_pk_bf16_f32 v44, v113, v113
    v_cvt_pk_bf16_f32 v47, v113, v112
    v_cvt_pk_bf16_f32 v48, v112, v112
    v_mov_b32 v45, v44
    v_mov_b32 v46, v44
    v_mov_b32 v49, v48
    ds_write_b128 v119, v[44:47] offset:16
    ds_write_b128 v119, v[46:49] offset:4256
    v_add_f32 v36, v36, v37
    v_add_f32 v36, v36, v38
    v_cvt_pk_bf16_f32 v40, v36, v36
    v_mov_b32 v41, v40
    v_mov_b32 v42, v40
    v_mov_b32 v43, v40
    ds_write_b128 v119, v[40:43]
    ds_write_b128 v119, v[42:45] offset:4240
    s_setprio 0
    v_and_b32 v10, 1, v4
    v_mul_u32_u24 v10, 4224, v10
    v_lshrrev_b32 v7, 1, v4
    v_sub_u32 v7, v5, v7
    v_lshl_add_u32 v10, v7, 4, v10
    s_add_u32 s15, s14, 576
    v_add_u32 v12, s15, v10
    v_and_b32 v10, 3, v4
    v_lshrrev_b32 v7, 2, v4
    v_mul_u32_u24 v3, 4128, v10
    s_mul_i32 s15, s5, 16512
    s_add_u32 s15, s15, 86016
    v_add_u32 v3, s15, v3
    v_lshl_add_u32 v8, v7, 3, v5
    v_lshl_add_u32 v13, v8, 4, v3
    v_add_u32 v13, 80, v13
    v_lshl_add_u32 v8, v7, 2, v5
    v_lshlrev_b32 v8, 5, v8
    v_lshl_add_u32 v8, v10, 2, v8
    v_add_u32 v8, s12, v8
    v_mov_b32 v9, 152192
    v_mov_b32 v16, 0
    v_mov_b32 v17, 0
    v_mov_b32 v18, 0
    v_mov_b32 v19, 0
    v_mov_b32 v20, 0
    v_mov_b32 v21, 0
    v_mov_b32 v22, 0
    v_mov_b32 v23, 0
    v_mov_b32 v24, 0
    v_mov_b32 v25, 0
    v_mov_b32 v26, 0
    v_mov_b32 v27, 0
    v_mov_b32 v28, 0
    v_mov_b32 v29, 0
    v_mov_b32 v30, 0
    v_mov_b32 v31, 0
    s_waitcnt vmcnt(0)
L_poll14:
    ds_read_b32 v124, v9 offset:8
    s_waitcnt lgkmcnt(0)
    v_readfirstlane_b32 s10, v124
    s_cmp_ge_u32 s10, 2
    s_cbranch_scc1 L_pdone15
    s_sleep 1
    s_branch L_poll14
L_pdone15:
    s_setprio 0
    v_subrev_u32 v1, 448, v12
    v_subrev_u32 v2, 448, v13
    ds_read_b128 v[32:35], v1 offset:1536
    v_subrev_u32 v11, 448, v13
    v_max_i32 v11, v11, v3
    ds_read_b128 v[36:39], v11
    ds_read_b128 v[40:43], v2 offset:512
    ds_read_b128 v[44:47], v2 offset:1024
    ds_read_b128 v[48:51], v2 offset:1536
    ds_read_b128 v[52:55], v1 offset:1024
    ds_read_b128 v[56:59], v1 offset:512
    ds_read_b128 v[60:63], v1 offset:0
    ds_read_b128 v[64:67], v1 offset:1600
    v_subrev_u32 v10, 384, v13
    v_max_i32 v10, v10, v3
    ds_read_b128 v[68:71], v10
    ds_read_b128 v[72:75], v2 offset:576
    ds_read_b128 v[76:79], v2 offset:1088
    ds_read_b128 v[80:83], v2 offset:1600
    ds_read_b128 v[84:87], v1 offset:1088
    s_waitcnt lgkmcnt(9)
    v_mfma_f32_16x16x32_bf16 v[16:19], v[32:35], v[36:39], v[16:19]
    ds_read_b128 v[88:91], v1 offset:576
    v_mfma_f32_16x16x32_bf16 v[20:23], v[32:35], v[40:43], v[20:23]
    v_mfma_f32_16x16x32_bf16 v[24:27], v[32:35], v[44:47], v[24:27]
    ds_read_b128 v[92:95], v1 offset:64
    v_mfma_f32_16x16x32_bf16 v[28:31], v[32:35], v[48:51], v[28:31]
    ds_read_b128 v[96:99], v1 offset:1664
    s_waitcnt lgkmcnt(10)
    v_mfma_f32_16x16x32_bf16 v[20:23], v[52:55], v[36:39], v[20:23]
    v_subrev_u32 v11, 320, v13
    v_max_i32 v11, v11, v3
    ds_read_b128 v[100:103], v11
    v_mfma_f32_16x16x32_bf16 v[24:27], v[52:55], v[40:43], v[24:27]
    ds_read_b128 v[104:107], v2 offset:640
    v_mfma_f32_16x16x32_bf16 v[28:31], v[52:55], v[44:47], v[28:31]
    ds_read_b128 v[108:111], v2 offset:1152
    v_mfma_f32_16x16x32_bf16 v[24:27], v[56:59], v[36:39], v[24:27]
    ds_read_b128 v[112:115], v2 offset:1664
    v_mfma_f32_16x16x32_bf16 v[28:31], v[56:59], v[40:43], v[28:31]
    ds_read_b128 v[116:119], v1 offset:1152
    s_waitcnt lgkmcnt(10)
    v_mfma_f32_16x16x32_bf16 v[28:31], v[60:63], v[36:39], v[28:31]
    v_mfma_f32_16x16x32_bf16 v[16:19], v[64:67], v[68:71], v[16:19]
    ds_read_b128 v[120:123], v1 offset:640
    v_mfma_f32_16x16x32_bf16 v[20:23], v[64:67], v[72:75], v[20:23]
    v_mfma_f32_16x16x32_bf16 v[24:27], v[64:67], v[76:79], v[24:27]
    ds_read_b128 v[32:35], v1 offset:128
    s_waitcnt lgkmcnt(10)
    v_mfma_f32_16x16x32_bf16 v[28:31], v[64:67], v[80:83], v[28:31]
    ds_read_b128 v[48:51], v1 offset:1728
    v_mfma_f32_16x16x32_bf16 v[20:23], v[84:87], v[68:71], v[20:23]
    v_subrev_u32 v10, 256, v13
    v_max_i32 v10, v10, v3
    ds_read_b128 v[52:55], v10
    v_mfma_f32_16x16x32_bf16 v[24:27], v[84:87], v[72:75], v[24:27]
    ds_read_b128 v[44:47], v2 offset:704
    v_mfma_f32_16x16x32_bf16 v[28:31], v[84:87], v[76:79], v[28:31]
    ds_read_b128 v[56:59], v2 offset:1216
    s_waitcnt lgkmcnt(10)
    v_mfma_f32_16x16x32_bf16 v[24:27], v[88:91], v[68:71], v[24:27]
    ds_read_b128 v[40:43], v2 offset:1728
    v_mfma_f32_16x16x32_bf16 v[28:31], v[88:91], v[72:75], v[28:31]
    ds_read_b128 v[60:63], v1 offset:1216
    v_mfma_f32_16x16x32_bf16 v[28:31], v[92:95], v[68:71], v[28:31]
    v_mfma_f32_16x16x32_bf16 v[16:19], v[96:99], v[100:103], v[16:19]
    ds_read_b128 v[36:39], v1 offset:704
    s_waitcnt lgkmcnt(9)
    v_mfma_f32_16x16x32_bf16 v[20:23], v[96:99], v[104:107], v[20:23]
    v_mfma_f32_16x16x32_bf16 v[24:27], v[96:99], v[108:111], v[24:27]
    ds_read_b128 v[64:67], v1 offset:192
    v_mfma_f32_16x16x32_bf16 v[28:31], v[96:99], v[112:115], v[28:31]
    ds_read_b128 v[80:83], v1 offset:1792
    v_mfma_f32_16x16x32_bf16 v[20:23], v[116:119], v[100:103], v[20:23]
    v_subrev_u32 v11, 192, v13
    v_max_i32 v11, v11, v3
    ds_read_b128 v[84:87], v11
    v_mfma_f32_16x16x32_bf16 v[24:27], v[116:119], v[104:107], v[24:27]
    ds_read_b128 v[76:79], v2 offset:768
    v_mfma_f32_16x16x32_bf16 v[28:31], v[116:119], v[108:111], v[28:31]
    ds_read_b128 v[88:91], v2 offset:1280
    s_waitcnt lgkmcnt(10)
    v_mfma_f32_16x16x32_bf16 v[24:27], v[120:123], v[100:103], v[24:27]
    ds_read_b128 v[72:75], v2 offset:1792
    v_mfma_f32_16x16x32_bf16 v[28:31], v[120:123], v[104:107], v[28:31]
    ds_read_b128 v[92:95], v1 offset:1280
    v_mfma_f32_16x16x32_bf16 v[28:31], v[32:35], v[100:103], v[28:31]
    v_mfma_f32_16x16x32_bf16 v[16:19], v[48:51], v[52:55], v[16:19]
    ds_read_b128 v[68:71], v1 offset:768
    s_waitcnt lgkmcnt(9)
    v_mfma_f32_16x16x32_bf16 v[20:23], v[48:51], v[44:47], v[20:23]
    v_mfma_f32_16x16x32_bf16 v[24:27], v[48:51], v[56:59], v[24:27]
    ds_read_b128 v[96:99], v1 offset:256
    v_mfma_f32_16x16x32_bf16 v[28:31], v[48:51], v[40:43], v[28:31]
    ds_read_b128 v[112:115], v1 offset:1856
    v_mfma_f32_16x16x32_bf16 v[20:23], v[60:63], v[52:55], v[20:23]
    v_subrev_u32 v10, 128, v13
    v_max_i32 v10, v10, v3
    ds_read_b128 v[116:119], v10
    v_mfma_f32_16x16x32_bf16 v[24:27], v[60:63], v[44:47], v[24:27]
    ds_read_b128 v[108:111], v2 offset:832
    v_mfma_f32_16x16x32_bf16 v[28:31], v[60:63], v[56:59], v[28:31]
    ds_read_b128 v[120:123], v2 offset:1344
    s_waitcnt lgkmcnt(10)
    v_mfma_f32_16x16x32_bf16 v[24:27], v[36:39], v[52:55], v[24:27]
    ds_read_b128 v[104:107], v2 offset:1856
    v_mfma_f32_16x16x32_bf16 v[28:31], v[36:39], v[44:47], v[28:31]
    ds_read_b128 v[32:35], v1 offset:1344
    v_mfma_f32_16x16x32_bf16 v[28:31], v[64:67], v[52:55], v[28:31]
    v_mfma_f32_16x16x32_bf16 v[16:19], v[80:83], v[84:87], v[16:19]
    ds_read_b128 v[100:103], v1 offset:832
    s_waitcnt lgkmcnt(9)
    v_mfma_f32_16x16x32_bf16 v[20:23], v[80:83], v[76:79], v[20:23]
    v_mfma_f32_16x16x32_bf16 v[24:27], v[80:83], v[88:91], v[24:27]
    ds_read_b128 v[48:51], v1 offset:320
    v_mfma_f32_16x16x32_bf16 v[28:31], v[80:83], v[72:75], v[28:31]
L_poll16:
    ds_read_b32 v124, v125 offset:20
    s_waitcnt lgkmcnt(0)
    v_readfirstlane_b32 s10, v124
    s_cmp_ge_u32 s10, 1
    s_cbranch_scc1 L_pdone17
    s_sleep 1
    s_branch L_poll16
L_pdone17:
    s_setprio 1
    ds_read_b128 v[40:43], v1 offset:1920
    v_mfma_f32_16x16x32_bf16 v[20:23], v[92:95], v[84:87], v[20:23]
    ds_read_b128 v[60:63], v2 offset:384
    v_mfma_f32_16x16x32_bf16 v[24:27], v[92:95], v[76:79], v[24:27]
    ds_read_b128 v[56:59], v2 offset:896
    v_mfma_f32_16x16x32_bf16 v[28:31], v[92:95], v[88:91], v[28:31]
    ds_read_b128 v[36:39], v2 offset:1408
    v_mfma_f32_16x16x32_bf16 v[24:27], v[68:71], v[84:87], v[24:27]
    ds_read_b128 v[44:47], v2 offset:1920
    v_mfma_f32_16x16x32_bf16 v[28:31], v[68:71], v[76:79], v[28:31]
    ds_read_b128 v[64:67], v1 offset:1408
    v_mfma_f32_16x16x32_bf16 v[28:31], v[96:99], v[84:87], v[28:31]
    v_mfma_f32_16x16x32_bf16 v[16:19], v[112:115], v[116:119], v[16:19]
    ds_read_b128 v[52:55], v1 offset:896
    v_mfma_f32_16x16x32_bf16 v[20:23], v[112:115], v[108:111], v[20:23]
    v_mfma_f32_16x16x32_bf16 v[24:27], v[112:115], v[120:123], v[24:27]
    ds_read_b128 v[80:83], v1 offset:384
    v_mfma_f32_16x16x32_bf16 v[28:31], v[112:115], v[104:107], v[28:31]
    ds_read_b128 v[72:75], v1 offset:1984
    v_mfma_f32_16x16x32_bf16 v[20:23], v[32:35], v[116:119], v[20:23]
    ds_read_b128 v[92:95], v2 offset:448
    v_mfma_f32_16x16x32_bf16 v[24:27], v[32:35], v[108:111], v[24:27]
    ds_read_b128 v[88:91], v2 offset:960
    v_mfma_f32_16x16x32_bf16 v[28:31], v[32:35], v[120:123], v[28:31]
    ds_read_b128 v[68:71], v2 offset:1472
    v_mfma_f32_16x16x32_bf16 v[24:27], v[100:103], v[116:119], v[24:27]
    ds_read_b128 v[76:79], v2 offset:1984
    v_mfma_f32_16x16x32_bf16 v[28:31], v[100:103], v[108:111], v[28:31]
    ds_read_b128 v[96:99], v1 offset:1472
    v_mfma_f32_16x16x32_bf16 v[28:31], v[48:51], v[116:119], v[28:31]
    s_waitcnt lgkmcnt(9)
    v_mfma_f32_16x16x32_bf16 v[16:19], v[40:43], v[60:63], v[16:19]
    ds_read_b128 v[84:87], v1 offset:960
    v_mfma_f32_16x16x32_bf16 v[20:23], v[40:43], v[56:59], v[20:23]
    v_mfma_f32_16x16x32_bf16 v[24:27], v[40:43], v[36:39], v[24:27]
    ds_read_b128 v[112:115], v1 offset:448
    v_mfma_f32_16x16x32_bf16 v[28:31], v[40:43], v[44:47], v[28:31]
L_bp18:
    ds_read_b32 v124, v125 offset:16
    ds_read_b32 v14, v9 offset:12
    s_waitcnt lgkmcnt(0)
    v_readfirstlane_b32 s46, v124
    v_readfirstlane_b32 s47, v14
    s_cmp_lt_u32 s46, 1
    s_cbranch_scc1 L_bps20
    s_cmp_lt_u32 s47, 2
    s_cbranch_scc1 L_bps20
    s_branch L_bpd19
L_bps20:
    s_sleep 0
    s_waitcnt lgkmcnt(0)
    s_branch L_bp18
L_bpd19:
    ds_read_b128 v[104:107], v1 offset:4032
    v_mfma_f32_16x16x32_bf16 v[20:23], v[64:67], v[60:63], v[20:23]
    ds_read_b128 v[32:35], v2 offset:2496
    v_mfma_f32_16x16x32_bf16 v[24:27], v[64:67], v[56:59], v[24:27]
    ds_read_b128 v[120:123], v2 offset:3008
    v_mfma_f32_16x16x32_bf16 v[28:31], v[64:67], v[36:39], v[28:31]
    ds_read_b128 v[100:103], v1 offset:3520
    v_mfma_f32_16x16x32_bf16 v[24:27], v[52:55], v[60:63], v[24:27]
    ds_read_b128 v[108:111], v2 offset:1984
    v_mfma_f32_16x16x32_bf16 v[28:31], v[52:55], v[56:59], v[28:31]
    ds_read_b128 v[48:51], v1 offset:3008
    v_mfma_f32_16x16x32_bf16 v[28:31], v[80:83], v[60:63], v[28:31]
    ds_read_b128 v[116:119], v2 offset:1472
    v_mfma_f32_16x16x32_bf16 v[16:19], v[72:75], v[92:95], v[16:19]
    v_mfma_f32_16x16x32_bf16 v[20:23], v[72:75], v[88:91], v[20:23]
    v_mfma_f32_16x16x32_bf16 v[24:27], v[72:75], v[68:71], v[24:27]
    ds_read_b128 v[40:43], v1 offset:2496
    v_mfma_f32_16x16x32_bf16 v[28:31], v[72:75], v[76:79], v[28:31]
    ds_read_b128 v[44:47], v2 offset:960
    v_mfma_f32_16x16x32_bf16 v[20:23], v[96:99], v[92:95], v[20:23]
    v_mfma_f32_16x16x32_bf16 v[24:27], v[96:99], v[88:91], v[24:27]
    v_mfma_f32_16x16x32_bf16 v[28:31], v[96:99], v[68:71], v[28:31]
    ds_read_b128 v[64:67], v1 offset:3968
    v_mfma_f32_16x16x32_bf16 v[24:27], v[84:87], v[92:95], v[24:27]
    ds_read_b128 v[36:39], v2 offset:2432
    v_mfma_f32_16x16x32_bf16 v[28:31], v[84:87], v[88:91], v[28:31]
    ds_read_b128 v[52:55], v2 offset:2944
    v_mfma_f32_16x16x32_bf16 v[28:31], v[112:115], v[92:95], v[28:31]
    ds_read_b128 v[56:59], v1 offset:3456
    s_waitcnt lgkmcnt(8)
    v_mfma_f32_16x16x32_bf16 v[16:19], v[104:107], v[32:35], v[16:19]
    ds_read_b128 v[80:83], v2 offset:1920
    v_mfma_f32_16x16x32_bf16 v[20:23], v[104:107], v[120:123], v[20:23]
    ds_read_b128 v[60:63], v1 offset:2944
    v_mfma_f32_16x16x32_bf16 v[16:19], v[100:103], v[108:111], v[16:19]
    ds_read_b128 v[72:75], v2 offset:1408
    v_mfma_f32_16x16x32_bf16 v[20:23], v[100:103], v[32:35], v[20:23]
    v_mfma_f32_16x16x32_bf16 v[24:27], v[100:103], v[120:123], v[24:27]
    s_waitcnt lgkmcnt(9)
    v_mfma_f32_16x16x32_bf16 v[16:19], v[48:51], v[116:119], v[16:19]
    ds_read_b128 v[76:79], v1 offset:2432
    v_mfma_f32_16x16x32_bf16 v[20:23], v[48:51], v[108:111], v[20:23]
    ds_read_b128 v[96:99], v2 offset:896
    v_mfma_f32_16x16x32_bf16 v[24:27], v[48:51], v[32:35], v[24:27]
    v_mfma_f32_16x16x32_bf16 v[28:31], v[48:51], v[120:123], v[28:31]
    s_waitcnt lgkmcnt(9)
    v_mfma_f32_16x16x32_bf16 v[16:19], v[40:43], v[44:47], v[16:19]
    ds_read_b128 v[68:71], v1 offset:3904
    v_mfma_f32_16x16x32_bf16 v[20:23], v[40:43], v[116:119], v[20:23]
    ds_read_b128 v[84:87], v2 offset:2368
    v_mfma_f32_16x16x32_bf16 v[24:27], v[40:43], v[108:111], v[24:27]
    ds_read_b128 v[88:91], v2 offset:2880
    v_mfma_f32_16x16x32_bf16 v[28:31], v[40:43], v[32:35], v[28:31]
    ds_read_b128 v[112:115], v1 offset:3392
    s_waitcnt lgkmcnt(8)
    v_mfma_f32_16x16x32_bf16 v[16:19], v[64:67], v[36:39], v[16:19]
    ds_read_b128 v[92:95], v2 offset:1856
    v_mfma_f32_16x16x32_bf16 v[20:23], v[64:67], v[52:55], v[20:23]
    ds_read_b128 v[104:107], v1 offset:2880
    v_mfma_f32_16x16x32_bf16 v[16:19], v[56:59], v[80:83], v[16:19]
    ds_read_b128 v[100:103], v2 offset:1344
    v_mfma_f32_16x16x32_bf16 v[20:23], v[56:59], v[36:39], v[20:23]
    v_mfma_f32_16x16x32_bf16 v[24:27], v[56:59], v[52:55], v[24:27]
    s_waitcnt lgkmcnt(9)
    v_mfma_f32_16x16x32_bf16 v[16:19], v[60:63], v[72:75], v[16:19]
    ds_read_b128 v[48:51], v1 offset:2368
    v_mfma_f32_16x16x32_bf16 v[20:23], v[60:63], v[80:83], v[20:23]
    ds_read_b128 v[120:123], v2 offset:832
    v_mfma_f32_16x16x32_bf16 v[24:27], v[60:63], v[36:39], v[24:27]
    v_mfma_f32_16x16x32_bf16 v[28:31], v[60:63], v[52:55], v[28:31]
    s_waitcnt lgkmcnt(9)
    v_mfma_f32_16x16x32_bf16 v[16:19], v[76:79], v[96:99], v[16:19]
    ds_read_b128 v[44:47], v1 offset:3840
    v_mfma_f32_16x16x32_bf16 v[20:23], v[76:79], v[72:75], v[20:23]
    ds_read_b128 v[116:119], v2 offset:2304
    v_mfma_f32_16x16x32_bf16 v[24:27], v[76:79], v[80:83], v[24:27]
    ds_read_b128 v[108:111], v2 offset:2816
    v_mfma_f32_16x16x32_bf16 v[28:31], v[76:79], v[36:39], v[28:31]
    ds_read_b128 v[40:43], v1 offset:3328
    s_waitcnt lgkmcnt(8)
    v_mfma_f32_16x16x32_bf16 v[16:19], v[68:71], v[84:87], v[16:19]
    ds_read_b128 v[32:35], v2 offset:1792
    v_mfma_f32_16x16x32_bf16 v[20:23], v[68:71], v[88:91], v[20:23]
    ds_read_b128 v[64:67], v1 offset:2816
    v_mfma_f32_16x16x32_bf16 v[16:19], v[112:115], v[92:95], v[16:19]
    ds_read_b128 v[56:59], v2 offset:1280
    v_mfma_f32_16x16x32_bf16 v[20:23], v[112:115], v[84:87], v[20:23]
    v_mfma_f32_16x16x32_bf16 v[24:27], v[112:115], v[88:91], v[24:27]
    s_waitcnt lgkmcnt(9)
    v_mfma_f32_16x16x32_bf16 v[16:19], v[104:107], v[100:103], v[16:19]
    ds_read_b128 v[60:63], v1 offset:2304
    v_mfma_f32_16x16x32_bf16 v[20:23], v[104:107], v[92:95], v[20:23]
    ds_read_b128 v[52:55], v2 offset:768
    v_mfma_f32_16x16x32_bf16 v[24:27], v[104:107], v[84:87], v[24:27]
    v_mfma_f32_16x16x32_bf16 v[28:31], v[104:107], v[88:91], v[28:31]
    s_waitcnt lgkmcnt(9)
    v_mfma_f32_16x16x32_bf16 v[16:19], v[48:51], v[120:123], v[16:19]
    ds_read_b128 v[96:99], v1 offset:3776
    v_mfma_f32_16x16x32_bf16 v[20:23], v[48:51], v[100:103], v[20:23]
    ds_read_b128 v[72:75], v2 offset:2240
    v_mfma_f32_16x16x32_bf16 v[24:27], v[48:51], v[92:95], v[24:27]
    ds_read_b128 v[80:83], v2 offset:2752
    v_mfma_f32_16x16x32_bf16 v[28:31], v[48:51], v[84:87], v[28:31]
    ds_read_b128 v[76:79], v1 offset:3264
    s_waitcnt lgkmcnt(8)
    v_mfma_f32_16x16x32_bf16 v[16:19], v[44:47], v[116:119], v[16:19]
    ds_read_b128 v[36:39], v2 offset:1728
    v_mfma_f32_16x16x32_bf16 v[20:23], v[44:47], v[108:111], v[20:23]
    ds_read_b128 v[68:71], v1 offset:2752
    v_mfma_f32_16x16x32_bf16 v[16:19], v[40:43], v[32:35], v[16:19]
    ds_read_b128 v[112:115], v2 offset:1216
    v_mfma_f32_16x16x32_bf16 v[20:23], v[40:43], v[116:119], v[20:23]
    v_mfma_f32_16x16x32_bf16 v[24:27], v[40:43], v[108:111], v[24:27]
    s_waitcnt lgkmcnt(9)
    v_mfma_f32_16x16x32_bf16 v[16:19], v[64:67], v[56:59], v[16:19]
    ds_read_b128 v[104:107], v1 offset:2240
    v_mfma_f32_16x16x32_bf16 v[20:23], v[64:67], v[32:35], v[20:23]
    ds_read_b128 v[88:91], v2 offset:704
    v_mfma_f32_16x16x32_bf16 v[24:27], v[64:67], v[116:119], v[24:27]
    v_mfma_f32_16x16x32_bf16 v[28:31], v[64:67], v[108:111], v[28:31]
    s_waitcnt lgkmcnt(9)
    v_mfma_f32_16x16x32_bf16 v[16:19], v[60:63], v[52:55], v[16:19]
    ds_read_b128 v[120:123], v1 offset:3712
    v_mfma_f32_16x16x32_bf16 v[20:23], v[60:63], v[56:59], v[20:23]
    ds_read_b128 v[100:103], v2 offset:2176
    v_mfma_f32_16x16x32_bf16 v[24:27], v[60:63], v[32:35], v[24:27]
    ds_read_b128 v[92:95], v2 offset:2688
    v_mfma_f32_16x16x32_bf16 v[28:31], v[60:63], v[116:119], v[28:31]
    ds_read_b128 v[48:51], v1 offset:3200
    s_waitcnt lgkmcnt(8)
    v_mfma_f32_16x16x32_bf16 v[16:19], v[96:99], v[72:75], v[16:19]
    ds_read_b128 v[84:87], v2 offset:1664
    v_mfma_f32_16x16x32_bf16 v[20:23], v[96:99], v[80:83], v[20:23]
    ds_read_b128 v[44:47], v1 offset:2688
    v_mfma_f32_16x16x32_bf16 v[16:19], v[76:79], v[36:39], v[16:19]
    ds_read_b128 v[40:43], v2 offset:1152
    v_mfma_f32_16x16x32_bf16 v[20:23], v[76:79], v[72:75], v[20:23]
    v_mfma_f32_16x16x32_bf16 v[24:27], v[76:79], v[80:83], v[24:27]
    s_waitcnt lgkmcnt(9)
    v_mfma_f32_16x16x32_bf16 v[16:19], v[68:71], v[112:115], v[16:19]
    ds_read_b128 v[64:67], v1 offset:2176
    v_mfma_f32_16x16x32_bf16 v[20:23], v[68:71], v[36:39], v[20:23]
    ds_read_b128 v[108:111], v2 offset:640
    v_mfma_f32_16x16x32_bf16 v[24:27], v[68:71], v[72:75], v[24:27]
    v_mfma_f32_16x16x32_bf16 v[28:31], v[68:71], v[80:83], v[28:31]
    s_waitcnt lgkmcnt(9)
    v_mfma_f32_16x16x32_bf16 v[16:19], v[104:107], v[88:91], v[16:19]
    ds_read_b128 v[52:55], v1 offset:3648
    v_mfma_f32_16x16x32_bf16 v[20:23], v[104:107], v[112:115], v[20:23]
    ds_read_b128 v[56:59], v2 offset:2112
    v_mfma_f32_16x16x32_bf16 v[24:27], v[104:107], v[36:39], v[24:27]
    ds_read_b128 v[32:35], v2 offset:2624
    v_mfma_f32_16x16x32_bf16 v[28:31], v[104:107], v[72:75], v[28:31]
    ds_read_b128 v[60:63], v1 offset:3136
    s_waitcnt lgkmcnt(8)
    v_mfma_f32_16x16x32_bf16 v[16:19], v[120:123], v[100:103], v[16:19]
    ds_read_b128 v[116:119], v2 offset:1600
    v_mfma_f32_16x16x32_bf16 v[20:23], v[120:123], v[92:95], v[20:23]
    ds_read_b128 v[96:99], v1 offset:2624
    v_mfma_f32_16x16x32_bf16 v[16:19], v[48:51], v[84:87], v[16:19]
    ds_read_b128 v[76:79], v2 offset:1088
    v_mfma_f32_16x16x32_bf16 v[20:23], v[48:51], v[100:103], v[20:23]
    v_mfma_f32_16x16x32_bf16 v[24:27], v[48:51], v[92:95], v[24:27]
    s_waitcnt lgkmcnt(9)
    v_mfma_f32_16x16x32_bf16 v[16:19], v[44:47], v[40:43], v[16:19]
    ds_read_b128 v[68:71], v1 offset:2112
    v_mfma_f32_16x16x32_bf16 v[20:23], v[44:47], v[84:87], v[20:23]
    ds_read_b128 v[80:83], v2 offset:576
    v_mfma_f32_16x16x32_bf16 v[24:27], v[44:47], v[100:103], v[24:27]
    v_mfma_f32_16x16x32_bf16 v[28:31], v[44:47], v[92:95], v[28:31]
    s_waitcnt lgkmcnt(9)
    v_mfma_f32_16x16x32_bf16 v[16:19], v[64:67], v[108:111], v[16:19]
    ds_read_b128 v[88:91], v1 offset:3584
    v_mfma_f32_16x16x32_bf16 v[20:23], v[64:67], v[40:43], v[20:23]
    ds_read_b128 v[112:115], v2 offset:2048
    v_mfma_f32_16x16x32_bf16 v[24:27], v[64:67], v[84:87], v[24:27]
    ds_read_b128 v[36:39], v2 offset:2560
    v_mfma_f32_16x16x32_bf16 v[28:31], v[64:67], v[100:103], v[28:31]
    ds_read_b128 v[104:107], v1 offset:3072
    s_waitcnt lgkmcnt(8)
    v_mfma_f32_16x16x32_bf16 v[16:19], v[52:55], v[56:59], v[16:19]
    ds_read_b128 v[72:75], v2 offset:1536
    v_mfma_f32_16x16x32_bf16 v[20:23], v[52:55], v[32:35], v[20:23]
    ds_read_b128 v[120:123], v1 offset:2560
    v_mfma_f32_16x16x32_bf16 v[16:19], v[60:63], v[116:119], v[16:19]
    ds_read_b128 v[48:51], v2 offset:1024
    v_mfma_f32_16x16x32_bf16 v[20:23], v[60:63], v[56:59], v[20:23]
    v_mfma_f32_16x16x32_bf16 v[24:27], v[60:63], v[32:35], v[24:27]
    s_waitcnt lgkmcnt(9)
    v_mfma_f32_16x16x32_bf16 v[16:19], v[96:99], v[76:79], v[16:19]
    ds_read_b128 v[44:47], v1 offset:2048
    v_mfma_f32_16x16x32_bf16 v[20:23], v[96:99], v[116:119], v[20:23]
    ds_read_b128 v[92:95], v2 offset:512
    v_mfma_f32_16x16x32_bf16 v[24:27], v[96:99], v[56:59], v[24:27]
    v_mfma_f32_16x16x32_bf16 v[28:31], v[96:99], v[32:35], v[28:31]
    s_waitcnt lgkmcnt(9)
    v_mfma_f32_16x16x32_bf16 v[16:19], v[68:71], v[80:83], v[16:19]
    ds_read_b128 v[108:111], v1 offset:4032
    v_mfma_f32_16x16x32_bf16 v[20:23], v[68:71], v[76:79], v[20:23]
    ds_read_b128 v[40:43], v2 offset:3520
    v_mfma_f32_16x16x32_bf16 v[24:27], v[68:71], v[116:119], v[24:27]
    ds_read_b128 v[84:87], v2 offset:4032
    v_mfma_f32_16x16x32_bf16 v[28:31], v[68:71], v[56:59], v[28:31]
    ds_read_b128 v[64:67], v1 offset:3520
    s_waitcnt lgkmcnt(8)
    v_mfma_f32_16x16x32_bf16 v[16:19], v[88:91], v[112:115], v[16:19]
    ds_read_b128 v[100:103], v1 offset:3968
    v_mfma_f32_16x16x32_bf16 v[20:23], v[88:91], v[36:39], v[20:23]
    ds_read_b128 v[52:55], v2 offset:3456
    v_mfma_f32_16x16x32_bf16 v[16:19], v[104:107], v[72:75], v[16:19]
    ds_read_b128 v[60:63], v2 offset:3968
    v_mfma_f32_16x16x32_bf16 v[20:23], v[104:107], v[112:115], v[20:23]
    ds_read_b128 v[96:99], v1 offset:3456
    v_mfma_f32_16x16x32_bf16 v[24:27], v[104:107], v[36:39], v[24:27]
    ds_read_b128 v[32:35], v1 offset:3904
    s_waitcnt lgkmcnt(11)
    v_mfma_f32_16x16x32_bf16 v[16:19], v[120:123], v[48:51], v[16:19]
    ds_read_b128 v[80:83], v2 offset:3392
    v_mfma_f32_16x16x32_bf16 v[20:23], v[120:123], v[72:75], v[20:23]
    ds_read_b128 v[76:79], v2 offset:3904
    v_mfma_f32_16x16x32_bf16 v[24:27], v[120:123], v[112:115], v[24:27]
    ds_read_b128 v[116:119], v1 offset:3392
    v_mfma_f32_16x16x32_bf16 v[28:31], v[120:123], v[36:39], v[28:31]
    ds_read_b128 v[68:71], v1 offset:3840
    s_waitcnt lgkmcnt(13)
    v_mfma_f32_16x16x32_bf16 v[16:19], v[44:47], v[92:95], v[16:19]
    ds_read_b128 v[56:59], v2 offset:3328
    v_mfma_f32_16x16x32_bf16 v[20:23], v[44:47], v[48:51], v[20:23]
    ds_read_b128 v[88:91], v2 offset:3840
    v_mfma_f32_16x16x32_bf16 v[24:27], v[44:47], v[72:75], v[24:27]
    v_mfma_f32_16x16x32_bf16 v[28:31], v[44:47], v[112:115], v[28:31]
    s_waitcnt lgkmcnt(9)
    v_mfma_f32_16x16x32_bf16 v[24:27], v[108:111], v[40:43], v[24:27]
    ds_read_b128 v[104:107], v1 offset:3328
    ds_read_b128 v[120:123], v1 offset:3776
    v_mfma_f32_16x16x32_bf16 v[28:31], v[108:111], v[84:87], v[28:31]
    ds_read_b128 v[36:39], v2 offset:3264
    ds_read_b128 v[92:95], v2 offset:3776
    v_mfma_f32_16x16x32_bf16 v[28:31], v[64:67], v[40:43], v[28:31]
    ds_read_b128 v[48:51], v1 offset:3264
    ds_read_b128 v[72:75], v1 offset:3712
    v_mfma_f32_16x16x32_bf16 v[24:27], v[100:103], v[52:55], v[24:27]
    s_waitcnt lgkmcnt(10)
    v_mfma_f32_16x16x32_bf16 v[28:31], v[100:103], v[60:63], v[28:31]
    ds_read_b128 v[44:47], v2 offset:3200
    ds_read_b128 v[112:115], v2 offset:3712
    v_cvt_pk_bf16_f32 v16, v16, v17
    v_cvt_pk_bf16_f32 v18, v18, v19
    ds_write_b32 v8, v16 offset:2048
    v_mfma_f32_16x16x32_bf16 v[28:31], v[96:99], v[52:55], v[28:31]
    ds_read_b128 v[108:111], v1 offset:3200
    ds_read_b128 v[84:87], v1 offset:3648
    v_mfma_f32_16x16x32_bf16 v[24:27], v[32:35], v[80:83], v[24:27]
    v_mfma_f32_16x16x32_bf16 v[28:31], v[32:35], v[76:79], v[28:31]
    s_waitcnt lgkmcnt(10)
    v_mfma_f32_16x16x32_bf16 v[28:31], v[116:119], v[80:83], v[28:31]
    ds_read_b128 v[64:67], v2 offset:3136
    ds_read_b128 v[40:43], v2 offset:3648
    ds_write_b32 v8, v18 offset:2064
    v_cvt_pk_bf16_f32 v20, v20, v21
    v_cvt_pk_bf16_f32 v22, v22, v23
    v_mfma_f32_16x16x32_bf16 v[24:27], v[68:71], v[56:59], v[24:27]
    ds_read_b128 v[100:103], v1 offset:3136
    ds_read_b128 v[60:63], v1 offset:3584
    v_mfma_f32_16x16x32_bf16 v[28:31], v[68:71], v[88:91], v[28:31]
    v_mfma_f32_16x16x32_bf16 v[28:31], v[104:107], v[56:59], v[28:31]
    s_waitcnt lgkmcnt(9)
    v_mfma_f32_16x16x32_bf16 v[24:27], v[120:123], v[36:39], v[24:27]
    ds_read_b128 v[96:99], v2 offset:3072
    ds_read_b128 v[52:55], v2 offset:3584
    ds_write_b32 v8, v20 offset:2560
    ds_write_b32 v8, v22 offset:2576
    s_mov_b64 exec, 1
    ds_add_u32 v9, v126 offset:20
    s_mov_b64 exec, -1
    v_mfma_f32_16x16x32_bf16 v[28:31], v[120:123], v[92:95], v[28:31]
    ds_read_b128 v[32:35], v1 offset:3072
    v_mfma_f32_16x16x32_bf16 v[28:31], v[48:51], v[36:39], v[28:31]
    v_mfma_f32_16x16x32_bf16 v[24:27], v[72:75], v[44:47], v[24:27]
    s_waitcnt lgkmcnt(9)
    v_mfma_f32_16x16x32_bf16 v[28:31], v[72:75], v[112:115], v[28:31]
    v_mfma_f32_16x16x32_bf16 v[28:31], v[108:111], v[44:47], v[28:31]
    v_mfma_f32_16x16x32_bf16 v[24:27], v[84:87], v[64:67], v[24:27]
    v_mfma_f32_16x16x32_bf16 v[28:31], v[84:87], v[40:43], v[28:31]
    s_waitcnt lgkmcnt(0)
    v_mfma_f32_16x16x32_bf16 v[28:31], v[100:103], v[64:67], v[28:31]
    v_mfma_f32_16x16x32_bf16 v[24:27], v[60:63], v[96:99], v[24:27]
    v_mfma_f32_16x16x32_bf16 v[28:31], v[60:63], v[52:55], v[28:31]
    v_mfma_f32_16x16x32_bf16 v[28:31], v[32:35], v[96:99], v[28:31]
    s_nop 5
    v_cvt_pk_bf16_f32 v24, v24, v25
    v_cvt_pk_bf16_f32 v26, v26, v27
    ds_write_b32 v8, v24 offset:3072
    ds_write_b32 v8, v26 offset:3088
    v_cvt_pk_bf16_f32 v28, v28, v29
    v_cvt_pk_bf16_f32 v30, v30, v31
    ds_write_b32 v8, v28 offset:3584
    ds_write_b32 v8, v30 offset:3600
    s_mov_b64 exec, 1
    ds_add_u32 v9, v126 offset:24
    s_mov_b64 exec, -1
    s_endpgm
L_io:
    s_sub_u32 s5, s3, 12
    s_lshl_b32 s6, s5, 6
    v_add_u32 v1, s6, v0
    v_mul_u32_u24 v2, 10240, v1
    s_lshl_b32 s7, s4, 3
    v_add_u32 v2, s7, v2
    v_subrev_u32 v3, 3840, v2
    s_movk_i32 s8, 5120
    v_mov_b32 v40, 0
    v_mov_b32 v41, 0
    v_mov_b32 v42, 0
    v_mov_b32 v43, 0
    v_lshrrev_b32 v4, 2, v0
    v_mul_u32_u24 v4, 16512, v4
    v_and_b32 v5, 3, v0
    v_mul_u32_u24 v5, 4128, v5
    v_add3_u32 v4, v4, v5, 0
    v_add_u32 v4, 86016, v4
    v_lshlrev_b32 v5, 2, v0
    v_add_u32 v5, 152064, v5
    s_mul_i32 s9, s5, 8448
    s_add_u32 s9, s9, 52224
    v_lshlrev_b32 v6, 2, v0
    v_add_u32 v6, s9, v6
    s_mov_b64 exec, 0xffff
    ds_write_b128 v4, v[40:43]
    s_mov_b32 exec_lo, -1
    s_mov_b32 exec_hi, 0xff
    ds_write_b32 v5, v40
    s_mov_b64 exec, 0x3fffffff
    ds_write_b32 v6, v40 offset:4104
    s_mov_b64 exec, 0xfffffff
    ds_write_b32 v6, v40 offset:8336
    s_mov_b64 exec, -1
    s_waitcnt lgkmcnt(0)
    s_mov_b32 s32, s16
    s_mov_b32 s33, s17
    s_mov_b32 s34, 2621440
    s_mov_b32 s35, 0x00020000
    s_mov_b32 s36, s30
    s_mov_b32 s37, s31
    s_mov_b32 s38, 2621440
    s_mov_b32 s39, 0x00020000
    global_load_dwordx4 v[120:123], v124, s[16:17]
    s_setprio 3
    v_lshlrev_b32 v6, 4, v1
    v_add_u32 v4, 86016, v6
    s_mov_b32 s44, 0x05040100
    s_mov_b32 s45, 0x07060302
    s_barrier
    s_load_dwordx2 s[42:43], s[28:29], s7
    s_cmp_lt_u32 s5, 2
    s_cbranch_scc1 L_io_go
L_poll21:
    ds_read_b32 v124, v125 offset:0
    s_waitcnt lgkmcnt(0)
    v_readfirstlane_b32 s10, v124
    s_cmp_ge_u32 s10, 2
    s_cbranch_scc1 L_pdone22
    s_sleep 1
    s_branch L_poll21
L_pdone22:
L_io_go:
    s_mov_b64 exec, 1
    buffer_load_dwordx2 v[10:11], v3, s[32:35], 0 offen offset:0
    buffer_load_dwordx2 v[12:13], v3, s[32:35], 0 offen offset:1280
    buffer_load_dwordx2 v[14:15], v3, s[32:35], 0 offen offset:2560
    s_mov_b64 exec, -1
    buffer_load_dwordx2 v[16:17], v2, s[32:35], 0 offen offset:0
    buffer_load_dwordx2 v[18:19], v2, s[32:35], 0 offen offset:1280
    buffer_load_dwordx2 v[20:21], v2, s[32:35], 0 offen offset:2560
    buffer_load_dwordx2 v[22:23], v2, s[32:35], 0 offen offset:3840
    buffer_load_dwordx2 v[24:25], v2, s[32:35], s8 offen offset:0
    buffer_load_dwordx2 v[26:27], v2, s[32:35], s8 offen offset:1280
    buffer_load_dwordx2 v[28:29], v2, s[32:35], s8 offen offset:2560
    buffer_load_dwordx2 v[30:31], v2, s[32:35], s8 offen offset:3840
    s_mov_b64 exec, 1
    ds_add_u32 v125, v126 offset:0
    s_mov_b64 exec, -1
    s_waitcnt lgkmcnt(0)
    s_lshl_b32 s46, s42, 16
    s_and_b32 s47, s42, 0xffff0000
    s_lshl_b32 s48, s43, 16
    s_and_b32 s49, s43, 0xffff0000
    s_lshr_b32 s9, s5, 1
    s_lshl_b32 s9, s9, 2
    v_add_u32 v5, s9, v125
    s_setprio 3
    s_waitcnt vmcnt(0)
    v_mov_b32_dpp v10, v26 wave_shr:1 row_mask:0xf bank_mask:0xf
    v_mov_b32_dpp v11, v27 wave_shr:1 row_mask:0xf bank_mask:0xf
    v_mov_b32_dpp v12, v28 wave_shr:1 row_mask:0xf bank_mask:0xf
    v_mov_b32_dpp v13, v29 wave_shr:1 row_mask:0xf bank_mask:0xf
    v_mov_b32_dpp v14, v30 wave_shr:1 row_mask:0xf bank_mask:0xf
    v_mov_b32_dpp v15, v31 wave_shr:1 row_mask:0xf bank_mask:0xf
    v_perm_b32 v40, v18, v16, s44
    v_perm_b32 v41, v22, v20, s44
    v_perm_b32 v42, v26, v24, s44
    v_perm_b32 v43, v30, v28, s44
    ds_write_b128 v4, v[40:43] offset:12400
    v_perm_b32 v44, v18, v16, s45
    v_perm_b32 v45, v22, v20, s45
    v_perm_b32 v46, v26, v24, s45
    v_perm_b32 v47, v30, v28, s45
    ds_write_b128 v4, v[44:47] offset:28912
    v_perm_b32 v48, v19, v17, s44
    v_perm_b32 v49, v23, v21, s44
    v_perm_b32 v50, v27, v25, s44
    v_perm_b32 v51, v31, v29, s44
    ds_write_b128 v4, v[48:51] offset:45424
    v_perm_b32 v52, v19, v17, s45
    v_perm_b32 v53, v23, v21, s45
    v_perm_b32 v54, v27, v25, s45
    v_perm_b32 v55, v31, v29, s45
    ds_write_b128 v4, v[52:55] offset:61936
    v_perm_b32 v40, v16, v14, s44
    v_perm_b32 v41, v20, v18, s44
    v_perm_b32 v42, v24, v22, s44
    v_perm_b32 v43, v28, v26, s44
    ds_write_b128 v4, v[40:43] offset:8272
    v_perm_b32 v44, v16, v14, s45
    v_perm_b32 v45, v20, v18, s45
    v_perm_b32 v46, v24, v22, s45
    v_perm_b32 v47, v28, v26, s45
    ds_write_b128 v4, v[44:47] offset:24784
    v_perm_b32 v48, v17, v15, s44
    v_perm_b32 v49, v21, v19, s44
    v_perm_b32 v50, v25, v23, s44
    v_perm_b32 v51, v29, v27, s44
    ds_write_b128 v4, v[48:51] offset:41296
    v_perm_b32 v52, v17, v15, s45
    v_perm_b32 v53, v21, v19, s45
    v_perm_b32 v54, v25, v23, s45
    v_perm_b32 v55, v29, v27, s45
    ds_write_b128 v4, v[52:55] offset:57808
    v_perm_b32 v40, v14, v12, s44
    v_perm_b32 v41, v18, v16, s44
    v_perm_b32 v42, v22, v20, s44
    v_perm_b32 v43, v26, v24, s44
    ds_write_b128 v4, v[40:43] offset:4144
    v_perm_b32 v44, v14, v12, s45
    v_perm_b32 v45, v18, v16, s45
    v_perm_b32 v46, v22, v20, s45
    v_perm_b32 v47, v26, v24, s45
    ds_write_b128 v4, v[44:47] offset:20656
    v_perm_b32 v48, v15, v13, s44
    v_perm_b32 v49, v19, v17, s44
    v_perm_b32 v50, v23, v21, s44
    v_perm_b32 v51, v27, v25, s44
    ds_write_b128 v4, v[48:51] offset:37168
    v_perm_b32 v52, v15, v13, s45
    v_perm_b32 v53, v19, v17, s45
    v_perm_b32 v54, v23, v21, s45
    v_perm_b32 v55, v27, v25, s45
    ds_write_b128 v4, v[52:55] offset:53680
    v_perm_b32 v40, v12, v10, s44
    v_perm_b32 v41, v16, v14, s44
    v_perm_b32 v42, v20, v18, s44
    v_perm_b32 v43, v24, v22, s44
    ds_write_b128 v4, v[40:43] offset:16
    v_perm_b32 v44, v12, v10, s45
    v_perm_b32 v45, v16, v14, s45
    v_perm_b32 v46, v20, v18, s45
    v_perm_b32 v47, v24, v22, s45
    ds_write_b128 v4, v[44:47] offset:16528
    v_perm_b32 v48, v13, v11, s44
    v_perm_b32 v49, v17, v15, s44
    v_perm_b32 v50, v21, v19, s44
    v_perm_b32 v51, v25, v23, s44
    ds_write_b128 v4, v[48:51] offset:33040
    v_perm_b32 v52, v13, v11, s45
    v_perm_b32 v53, v17, v15, s45
    v_perm_b32 v54, v21, v19, s45
    v_perm_b32 v55, v25, v23, s45
    ds_write_b128 v4, v[52:55] offset:49552
    s_mov_b64 exec, 1
    ds_add_u32 v5, v126 offset:8
    s_mov_b64 exec, -1
    s_setprio 0
    v_lshlrev_b32 v64, 16, v16
    v_and_b32 v65, 0xffff0000, v16
    v_mul_f32 v64, s46, v64
    v_mul_f32 v65, s47, v65
    v_cvt_pk_bf16_f32 v65, v64, v65
    v_lshlrev_b32 v64, 16, v65
    v_and_b32 v65, 0xffff0000, v65
    v_lshlrev_b32 v66, 16, v17
    v_and_b32 v67, 0xffff0000, v17
    v_mul_f32 v66, s48, v66
    v_mul_f32 v67, s49, v67
    v_cvt_pk_bf16_f32 v67, v66, v67
    v_lshlrev_b32 v66, 16, v67
    v_and_b32 v67, 0xffff0000, v67
    v_lshlrev_b32 v68, 16, v18
    v_and_b32 v69, 0xffff0000, v18
    v_mul_f32 v68, s46, v68
    v_mul_f32 v69, s47, v69
    v_cvt_pk_bf16_f32 v69, v68, v69
    v_lshlrev_b32 v68, 16, v69
    v_and_b32 v69, 0xffff0000, v69
    v_lshlrev_b32 v70, 16, v19
    v_and_b32 v71, 0xffff0000, v19
    v_mul_f32 v70, s48, v70
    v_mul_f32 v71, s49, v71
    v_cvt_pk_bf16_f32 v71, v70, v71
    v_lshlrev_b32 v70, 16, v71
    v_and_b32 v71, 0xffff0000, v71
    v_lshlrev_b32 v72, 16, v20
    v_and_b32 v73, 0xffff0000, v20
    v_mul_f32 v72, s46, v72
    v_mul_f32 v73, s47, v73
    v_cvt_pk_bf16_f32 v73, v72, v73
    v_lshlrev_b32 v72, 16, v73
    v_and_b32 v73, 0xffff0000, v73
    v_lshlrev_b32 v74, 16, v21
    v_and_b32 v75, 0xffff0000, v21
    v_mul_f32 v74, s48, v74
    v_mul_f32 v75, s49, v75
    v_cvt_pk_bf16_f32 v75, v74, v75
    v_lshlrev_b32 v74, 16, v75
    v_and_b32 v75, 0xffff0000, v75
    v_lshlrev_b32 v76, 16, v22
    v_and_b32 v77, 0xffff0000, v22
    v_mul_f32 v76, s46, v76
    v_mul_f32 v77, s47, v77
    v_cvt_pk_bf16_f32 v77, v76, v77
    v_lshlrev_b32 v76, 16, v77
    v_and_b32 v77, 0xffff0000, v77
    v_lshlrev_b32 v78, 16, v23
    v_and_b32 v79, 0xffff0000, v23
    v_mul_f32 v78, s48, v78
    v_mul_f32 v79, s49, v79
    v_cvt_pk_bf16_f32 v79, v78, v79
    v_lshlrev_b32 v78, 16, v79
    v_and_b32 v79, 0xffff0000, v79
    v_lshlrev_b32 v80, 16, v24
    v_and_b32 v81, 0xffff0000, v24
    v_mul_f32 v80, s46, v80
    v_mul_f32 v81, s47, v81
    v_cvt_pk_bf16_f32 v81, v80, v81
    v_lshlrev_b32 v80, 16, v81
    v_and_b32 v81, 0xffff0000, v81
    v_lshlrev_b32 v82, 16, v25
    v_and_b32 v83, 0xffff0000, v25
    v_mul_f32 v82, s48, v82
    v_mul_f32 v83, s49, v83
    v_cvt_pk_bf16_f32 v83, v82, v83
    v_lshlrev_b32 v82, 16, v83
    v_and_b32 v83, 0xffff0000, v83
    v_lshlrev_b32 v84, 16, v26
    v_and_b32 v85, 0xffff0000, v26
    v_mul_f32 v84, s46, v84
    v_mul_f32 v85, s47, v85
    v_cvt_pk_bf16_f32 v85, v84, v85
    v_lshlrev_b32 v84, 16, v85
    v_and_b32 v85, 0xffff0000, v85
    v_lshlrev_b32 v86, 16, v27
    v_and_b32 v87, 0xffff0000, v27
    v_mul_f32 v86, s48, v86
    v_mul_f32 v87, s49, v87
    v_cvt_pk_bf16_f32 v87, v86, v87
    v_lshlrev_b32 v86, 16, v87
    v_and_b32 v87, 0xffff0000, v87
    v_lshlrev_b32 v88, 16, v28
    v_and_b32 v89, 0xffff0000, v28
    v_mul_f32 v88, s46, v88
    v_mul_f32 v89, s47, v89
    v_cvt_pk_bf16_f32 v89, v88, v89
    v_lshlrev_b32 v88, 16, v89
    v_and_b32 v89, 0xffff0000, v89
    v_lshlrev_b32 v90, 16, v29
    v_and_b32 v91, 0xffff0000, v29
    v_mul_f32 v90, s48, v90
    v_mul_f32 v91, s49, v91
    v_cvt_pk_bf16_f32 v91, v90, v91
    v_lshlrev_b32 v90, 16, v91
    v_and_b32 v91, 0xffff0000, v91
    v_lshlrev_b32 v92, 16, v30
    v_and_b32 v93, 0xffff0000, v30
    v_mul_f32 v92, s46, v92
    v_mul_f32 v93, s47, v93
    v_cvt_pk_bf16_f32 v93, v92, v93
    v_lshlrev_b32 v92, 16, v93
    v_and_b32 v93, 0xffff0000, v93
    v_lshlrev_b32 v94, 16, v31
    v_and_b32 v95, 0xffff0000, v31
    v_mul_f32 v94, s48, v94
    v_mul_f32 v95, s49, v95
    v_cvt_pk_bf16_f32 v95, v94, v95
    v_lshlrev_b32 v94, 16, v95
    v_and_b32 v95, 0xffff0000, v95
    s_max_u32 s9, s5, 1
    s_sub_u32 s9, s9, 1
    s_lshl_b32 s9, s9, 2
    v_add_u32 v5, s9, v125
L_poll23:
    ds_read_b32 v124, v5 offset:16
    s_waitcnt lgkmcnt(0)
    v_readfirstlane_b32 s10, v124
    s_cmp_ge_u32 s10, 4
    s_cbranch_scc1 L_pdone24
    s_sleep 2
    s_branch L_poll23
L_pdone24:
    s_setprio 1
    ds_read_b128 v[40:43], v6 offset:0
    ds_read_b128 v[44:47], v6 offset:4352
    ds_read_b128 v[48:51], v6 offset:8704
    ds_read_b128 v[52:55], v6 offset:13056
    s_waitcnt lgkmcnt(0)
    v_lshlrev_b32 v20, 16, v40
    v_lshlrev_b32 v21, 16, v44
    v_lshlrev_b32 v22, 16, v48
    v_lshlrev_b32 v23, 16, v52
    v_add_f32 v20, v20, v64
    v_add_f32 v21, v21, v65
    v_add_f32 v22, v22, v66
    v_add_f32 v23, v23, v67
    v_cvt_pk_bf16_f32 v10, v20, v21
    v_cvt_pk_bf16_f32 v11, v22, v23
    buffer_store_dwordx2 v[10:11], v2, s[36:39], 0 offen offset:0
    v_lshlrev_b32 v20, 16, v41
    v_lshlrev_b32 v21, 16, v45
    v_lshlrev_b32 v22, 16, v49
    v_lshlrev_b32 v23, 16, v53
    v_add_f32 v20, v20, v68
    v_add_f32 v21, v21, v69
    v_add_f32 v22, v22, v70
    v_add_f32 v23, v23, v71
    v_cvt_pk_bf16_f32 v12, v20, v21
    v_cvt_pk_bf16_f32 v13, v22, v23
    buffer_store_dwordx2 v[12:13], v2, s[36:39], 0 offen offset:1280
    v_lshlrev_b32 v20, 16, v42
    v_lshlrev_b32 v21, 16, v46
    v_lshlrev_b32 v22, 16, v50
    v_lshlrev_b32 v23, 16, v54
    v_add_f32 v20, v20, v72
    v_add_f32 v21, v21, v73
    v_add_f32 v22, v22, v74
    v_add_f32 v23, v23, v75
    v_cvt_pk_bf16_f32 v14, v20, v21
    v_cvt_pk_bf16_f32 v15, v22, v23
    buffer_store_dwordx2 v[14:15], v2, s[36:39], 0 offen offset:2560
    v_lshlrev_b32 v20, 16, v43
    v_lshlrev_b32 v21, 16, v47
    v_lshlrev_b32 v22, 16, v51
    v_lshlrev_b32 v23, 16, v55
    v_add_f32 v20, v20, v76
    v_add_f32 v21, v21, v77
    v_add_f32 v22, v22, v78
    v_add_f32 v23, v23, v79
    v_cvt_pk_bf16_f32 v16, v20, v21
    v_cvt_pk_bf16_f32 v17, v22, v23
    buffer_store_dwordx2 v[16:17], v2, s[36:39], 0 offen offset:3840
    v_and_b32 v20, 0xffff0000, v40
    v_and_b32 v21, 0xffff0000, v44
    v_and_b32 v22, 0xffff0000, v48
    v_and_b32 v23, 0xffff0000, v52
    v_add_f32 v20, v20, v80
    v_add_f32 v21, v21, v81
    v_add_f32 v22, v22, v82
    v_add_f32 v23, v23, v83
    v_cvt_pk_bf16_f32 v10, v20, v21
    v_cvt_pk_bf16_f32 v11, v22, v23
    buffer_store_dwordx2 v[10:11], v2, s[36:39], s8 offen offset:0
    v_and_b32 v20, 0xffff0000, v41
    v_and_b32 v21, 0xffff0000, v45
    v_and_b32 v22, 0xffff0000, v49
    v_and_b32 v23, 0xffff0000, v53
    v_add_f32 v20, v20, v84
    v_add_f32 v21, v21, v85
    v_add_f32 v22, v22, v86
    v_add_f32 v23, v23, v87
    v_cvt_pk_bf16_f32 v12, v20, v21
    v_cvt_pk_bf16_f32 v13, v22, v23
    buffer_store_dwordx2 v[12:13], v2, s[36:39], s8 offen offset:1280
    v_and_b32 v20, 0xffff0000, v42
    v_and_b32 v21, 0xffff0000, v46
    v_and_b32 v22, 0xffff0000, v50
    v_and_b32 v23, 0xffff0000, v54
    v_add_f32 v20, v20, v88
    v_add_f32 v21, v21, v89
    v_add_f32 v22, v22, v90
    v_add_f32 v23, v23, v91
    v_cvt_pk_bf16_f32 v14, v20, v21
    v_cvt_pk_bf16_f32 v15, v22, v23
    buffer_store_dwordx2 v[14:15], v2, s[36:39], s8 offen offset:2560
    v_and_b32 v20, 0xffff0000, v43
    v_and_b32 v21, 0xffff0000, v47
    v_and_b32 v22, 0xffff0000, v51
    v_and_b32 v23, 0xffff0000, v55
    v_add_f32 v20, v20, v92
    v_add_f32 v21, v21, v93
    v_add_f32 v22, v22, v94
    v_add_f32 v23, v23, v95
    v_cvt_pk_bf16_f32 v16, v20, v21
    v_cvt_pk_bf16_f32 v17, v22, v23
    buffer_store_dwordx2 v[16:17], v2, s[36:39], s8 offen offset:3840
L_end:
    s_endpgm
L_code_end:
.section .rodata,"a"
.p2align 6
.amdhsa_kernel standalone__ssm_conv_s4d__prompt_kernel
  .amdhsa_next_free_vgpr 128
  .amdhsa_next_free_sgpr 64
  .amdhsa_accum_offset 128
  .amdhsa_group_segment_fixed_size 0
  .amdhsa_kernarg_size 80
  .amdhsa_user_sgpr_count 2
  .amdhsa_user_sgpr_kernarg_segment_ptr 1
  .amdhsa_system_sgpr_workgroup_id_x 1
.end_amdhsa_kernel
```
